```python
import torch

def _softmax(x, axis=-1):
    return torch.softmax(x, dim=axis)

def _gelu(x):
    return torch.nn.functional.gelu(x, approximate='tanh')

def _silu(x):
    return torch.nn.functional.silu(x)

def _sigmoid(x):
    return torch.sigmoid(x)

def _layernorm(x, axis=-1, eps=1e-05):
    m = x.mean(dim=axis, keepdim=True)
    v = x.var(dim=axis, keepdim=True, unbiased=False)
    return (x - m) / torch.sqrt(v + eps)

def _scatter_add(tgt, idx, src, axis=0):
    return tgt.clone().index_add_(axis, idx, src)

def _segment_sum(src, seg, n):
    out = torch.zeros((n,) + src.shape[1:], dtype=src.dtype)
    return out.index_add_(0, seg, src)

def _pad(x, pw):
    flat = tuple((v for pair in reversed(pw) for v in pair))
    return torch.nn.functional.pad(x, flat)
kernel_name = 'interleave_layers__ssm_conv_h3__memory_aug_recurrent_mem_tr__prompt'

def setup_inputs():

    _w = lambda a: (lambda t: t.to(torch.bfloat16) if t.is_floating_point() else t)(torch.as_tensor(a))

    def _A_setup():
        B, S, D = (1, 2048, 448)
        ks = 4
        return {'q': _w((lambda *s: torch.randn(*s, dtype=torch.bfloat16) * 0.05)(B, S, D)), 'k': _w((lambda *s: torch.randn(*s, dtype=torch.bfloat16) * 0.2)(B, S, D)), 'v': _w((lambda *s: torch.randn(*s, dtype=torch.bfloat16) * 0.2)(B, S, D)), 'shift_k': _w((lambda *s: torch.randn(*s, dtype=torch.bfloat16) * 0.2)(D, ks) * 0.5), 'ssm_k': _w((lambda *s: torch.randn(*s, dtype=torch.bfloat16) * 0.2)(D, S) * (1.0 / S ** 0.5)), 'ssm_D': _w((lambda *s: torch.randn(*s, dtype=torch.bfloat16) * 0.2)(D))}
    _A_in = _A_setup()

    def _B_setup():
        B, S, Dm = (1, 2048, 448)
        H, Dh = (16, 256)
        M, seg = (8, 32)
        seg = min(seg, S)
        S = S // seg * seg
        return {'x': _w((lambda *s: torch.randn(*s, dtype=torch.bfloat16) * 0.05)(B, S, Dm)), 'mem0': _w((lambda *s: torch.randn(*s, dtype=torch.bfloat16) * 0.2)(B, M, Dm)), 'Wq': _w((lambda *s: torch.randn(*s, dtype=torch.bfloat16) * 1.6)(Dm, H, Dh) * Dm ** (-0.5)), 'Wk': _w((lambda *s: torch.randn(*s, dtype=torch.bfloat16) * 1.6)(Dm, H, Dh) * Dm ** (-0.5)), 'Wv': _w((lambda *s: torch.randn(*s, dtype=torch.bfloat16) * 0.2)(Dm, H, Dh) * Dm ** (-0.5)), 'Wo': _w((lambda *s: torch.randn(*s, dtype=torch.bfloat16) * 0.2)(H, Dh, Dm) * (H * Dh) ** (-0.5)), 'seg_len': seg}
    _B_in = _B_setup()
    return {'A_q': _A_in['q'], 'A_k': _A_in['k'], 'A_v': _A_in['v'], 'A_shift_k': _A_in['shift_k'], 'A_ssm_k': _A_in['ssm_k'], 'A_ssm_D': _A_in['ssm_D'], 'B_x': _B_in['x'], 'B_mem0': _B_in['mem0'], 'B_Wq': _B_in['Wq'], 'B_Wk': _B_in['Wk'], 'B_Wv': _B_in['Wv'], 'B_Wo': _B_in['Wo'], 'B_seg_len': _B_in['seg_len']}

def reference(A_q, A_k, A_v, A_shift_k, A_ssm_k, A_ssm_D, B_x, B_mem0, B_Wq, B_Wk, B_Wv, B_Wo, B_seg_len):

    def _A_ref(q, k, v, shift_k, ssm_k, ssm_D):
        B, S, D = q.shape
        ks = shift_k.shape[-1]
        k_pad = _pad(k, ((0, 0), (ks - 1, 0), (0, 0)))
        k_shift = torch.zeros_like(k)
        for t in range(ks):
            k_shift = k_shift + k_pad[:, t:t + S, :] * shift_k[:, ks - 1 - t][None, None, :]
        kv = k_shift * v
        L = 2 * S
        kv_pad = _pad(kv, ((0, 0), (0, S), (0, 0)))
        kf_pad = _pad(ssm_k, ((0, 0), (0, S)))
        kv_f = (lambda x, axes=(-2, -1): torch.fft.rfft2(x.float(), dim=axes))(kv_pad[:, None, :, :], axes=(1, 2))
        kf_f = (lambda x, axes=(-2, -1): torch.fft.rfft2(x.float(), dim=axes))(kf_pad[:, None, :], axes=(1, 2))
        kf_f = (lambda x, *d: x.permute(*d))(kf_f, 1, 2, 0)
        y_f = kv_f * kf_f[None, :, :, :]
        y = (lambda x, s, axes=(-2, -1): torch.fft.irfft2(x, s=s, dim=axes).to(torch.bfloat16))(y_f, (1, L), axes=(1, 2))[:, 0, :S, :]
        y = y + kv * ssm_D[None, None, :]
        return q * y

    def _B_ref(x, mem0, Wq, Wk, Wv, Wo, seg_len):
        B, S, Dm = x.shape
        H, Dh = (Wq.shape[1], Wq.shape[2])
        M = mem0.shape[1]
        scale = Dh ** (-0.5)
        n_seg = S // seg_len
        L = M + seg_len
        idx = torch.arange(L)
        mask = (idx[:, None] < M) | (idx[:, None] >= idx[None, :])
        mem = mem0
        outs = []
        for s in range(n_seg):
            xs = x[:, s * seg_len:(s + 1) * seg_len, :].clone()
            h = torch.concatenate([mem, xs], axis=1)
            q = torch.einsum('btd,dhe->bhte', h, Wq)
            k = torch.einsum('btd,dhe->bhte', h, Wk)
            v = torch.einsum('btd,dhe->bhte', h, Wv)
            scores = torch.einsum('bhqe,bhke->bhqk', q, k) * scale
            scores = torch.where(mask[None, None], scores, -1000000000.0)
            p = _softmax(scores, axis=-1)
            o = torch.einsum('bhqk,bhke->bhqe', p, v)
            o = torch.einsum('bhte,hed->btd', o, Wo)
            mem = o[:, :M, :].clone()
            outs.append(o[:, M:, :])
        return torch.concatenate(outs, axis=1)
    x = A_q
    x = x + _A_ref(_layernorm(x, axis=-1), A_k, A_v, A_shift_k, A_ssm_k, A_ssm_D)
    x = x + _B_ref(_layernorm(x, axis=-1), B_mem0, B_Wq, B_Wk, B_Wv, B_Wo, B_seg_len)
    x = x + _A_ref(_layernorm(x, axis=-1), A_k, A_v, A_shift_k, A_ssm_k, A_ssm_D)
    x = x + _B_ref(_layernorm(x, axis=-1), B_mem0, B_Wq, B_Wk, B_Wv, B_Wo, B_seg_len)
    return x
```

```asm
; @launch kernel=zero_kernel grid=(1792,1,1) block=(256,1,1) lds=0
; @launch kernel=prep_kernel grid=(2016,1,1) block=(256,1,1) lds=8704
; @launch kernel=conv_kernel grid=(224,1,1) block=(256,1,1) lds=45056
; @launch kernel=row0_kernel grid=(64,1,1) block=(256,1,1) lds=29184
; @launch kernel=gqkv_kernel grid=(3072,1,1) block=(256,1,1) lds=0
; @launch kernel=chain0_kernel grid=(64,1,1) block=(256,1,1) lds=16384
; @launch kernel=attn_kernel grid=(1024,1,1) block=(256,1,1) lds=40960
; @launch kernel=go1_kernel grid=(112,1,1) block=(256,1,1) lds=0
; @launch kernel=row1_kernel grid=(64,1,1) block=(256,1,1) lds=29184
; @launch kernel=gqkv_kernel grid=(3072,1,1) block=(256,1,1) lds=0
; @launch kernel=chain1_kernel grid=(64,1,1) block=(256,1,1) lds=16384
; @launch kernel=attn_kernel grid=(1024,1,1) block=(256,1,1) lds=40960
; @launch kernel=go2_kernel grid=(112,1,1) block=(256,1,1) lds=0
.amdgcn_target "amdgcn-amd-amdhsa--gfx950"
.text
.globl zero_kernel
.p2align 8
.type zero_kernel,@function
zero_kernel:
    s_load_dwordx16 s[36:51], s[0:1], 0
    s_load_dwordx8 s[52:59], s[0:1], 64
    s_load_dwordx2 s[60:61], s[0:1], 104
    s_load_dwordx2 s[62:63], s[0:1], 120
    s_waitcnt lgkmcnt(0)
    s_add_u32 s4, s62, 134217728
    s_addc_u32 s5, s63, 0
    s_mov_b32 s6, 7340032
    s_mov_b32 s7, 0x20000
    v_mov_b32 v4, 0
    v_mov_b32 v5, 0
    v_mov_b32 v6, 0
    v_mov_b32 v7, 0
    s_lshl_b32 s8, s2, 12
    v_lshl_add_u32 v1, v0, 4, s8
    buffer_store_dwordx4 v[4:7], v1, s[4:7], 0 offen
    s_endpgm
.globl prep_kernel
.p2align 8
.type prep_kernel,@function
prep_kernel:
    s_load_dwordx16 s[36:51], s[0:1], 0
    s_load_dwordx8 s[52:59], s[0:1], 64
    s_load_dwordx2 s[60:61], s[0:1], 104
    s_load_dwordx2 s[62:63], s[0:1], 120
    s_waitcnt lgkmcnt(0)
    s_cmp_ge_u32 s2, 2016
    s_cbranch_scc1 prep_end
    v_lshrrev_b32 v1, 2, v0
    v_and_b32 v2, 3, v0
    s_cmp_ge_u32 s2, 1344
    s_cbranch_scc1 prep_b
    s_lshr_b32 s4, s2, 6
    s_mul_hi_u32 s5, s4, 0x24924925
    s_mul_i32 s6, s5, 7
    s_sub_u32 s6, s4, s6
    s_and_b32 s7, s2, 63
    s_lshl_b32 s8, s5, 3
    s_add_u32 s8, s8, 64
    s_load_dwordx2 s[12:13], s[0:1], s8
    s_waitcnt lgkmcnt(0)
    s_mov_b32 s14, 3670016
    s_mov_b32 s15, 0x20000
    s_lshl_b32 s9, s6, 19
    s_lshl_b32 s10, s7, 7
    s_add_u32 s9, s9, s10
    s_mov_b32 s20, 8192
    s_add_u32 s16, s62, 16777216
    s_addc_u32 s17, s63, 0
    s_mov_b32 s18, 11010048
    s_mov_b32 s19, 0x20000
    s_lshl_b32 s10, s5, 6
    s_add_u32 s10, s10, s7
    s_mul_i32 s10, s10, 57344
    s_lshl_b32 s11, s6, 7
    s_add_u32 s10, s10, s11
    s_mov_b32 s21, 896
    s_branch prep_ld
prep_b:
    s_cmp_ge_u32 s2, 1792
    s_cbranch_scc1 prep_c
    s_sub_u32 s4, s2, 1344
    s_mul_hi_u32 s6, s4, 0x24924925
    s_mul_i32 s7, s6, 7
    s_sub_u32 s7, s4, s7
    s_mov_b32 s12, s58
    s_mov_b32 s13, s59
    s_mov_b32 s14, 3670016
    s_mov_b32 s15, 0x20000
    s_mul_i32 s9, s6, 57344
    s_lshl_b32 s10, s7, 7
    s_add_u32 s9, s9, s10
    s_mov_b32 s20, 896
    s_add_u32 s16, s62, 29360128
    s_addc_u32 s17, s63, 0
    s_mov_b32 s18, 3670016
    s_mov_b32 s19, 0x20000
    s_lshl_b32 s10, s7, 19
    s_lshl_b32 s11, s6, 7
    s_add_u32 s10, s10, s11
    s_mov_b32 s21, 8192
prep_ld:
    v_mul_lo_u32 v3, v1, s20
    v_lshl_add_u32 v3, v2, 5, v3
    v_add_u32 v3, s9, v3
    buffer_load_dwordx4 v[8:11], v3, s[12:15], 0 offen
    buffer_load_dwordx4 v[12:15], v3, s[12:15], 0 offen offset:16
    s_waitcnt vmcnt(0)
    s_branch prep_tr
prep_c:
    s_sub_u32 s4, s2, 1792
    s_mul_hi_u32 s6, s4, 0x24924925
    s_mul_i32 s7, s6, 7
    s_sub_u32 s7, s4, s7
    s_mov_b32 s12, s38
    s_mov_b32 s13, s39
    s_mov_b32 s14, 1835008
    s_mov_b32 s15, 0x20000
    s_mov_b32 s24, s40
    s_mov_b32 s25, s41
    s_mov_b32 s26, 1835008
    s_mov_b32 s27, 0x20000
    s_mov_b32 s28, s42
    s_mov_b32 s29, s43
    s_mov_b32 s30, 3584
    s_mov_b32 s31, 0x20000
    s_mul_i32 s9, s6, 57344
    s_lshl_b32 s10, s7, 7
    s_add_u32 s9, s9, s10
    s_add_u32 s16, s62, 0
    s_addc_u32 s17, s63, 0
    s_mov_b32 s18, 1835008
    s_mov_b32 s19, 0x20000
    s_lshl_b32 s10, s7, 18
    s_lshl_b32 s11, s6, 7
    s_add_u32 s10, s10, s11
    s_mov_b32 s21, 4096
    s_mov_b32 s20, 896
    v_mul_lo_u32 v3, v1, s20
    v_lshl_add_u32 v3, v2, 5, v3
    v_add_u32 v3, s9, v3
    v_subrev_u32 v4, 2688, v3
    buffer_load_dwordx4 v[16:19], v4, s[12:15], 0 offen offset:0
    buffer_load_dwordx4 v[20:23], v4, s[12:15], 0 offen offset:16
    buffer_load_dwordx4 v[24:27], v4, s[12:15], 0 offen offset:896
    buffer_load_dwordx4 v[28:31], v4, s[12:15], 0 offen offset:912
    buffer_load_dwordx4 v[32:35], v4, s[12:15], 0 offen offset:1792
    buffer_load_dwordx4 v[36:39], v4, s[12:15], 0 offen offset:1808
    buffer_load_dwordx4 v[40:43], v4, s[12:15], 0 offen offset:2688
    buffer_load_dwordx4 v[44:47], v4, s[12:15], 0 offen offset:2704
    buffer_load_dwordx4 v[48:51], v3, s[24:27], 0 offen offset:0
    buffer_load_dwordx4 v[52:55], v3, s[24:27], 0 offen offset:16
    s_lshl_b32 s11, s7, 9
    v_lshlrev_b32 v5, 7, v2
    v_add_u32 v5, s11, v5
    buffer_load_dwordx4 v[56:59], v5, s[28:31], 0 offen offset:0
    buffer_load_dwordx4 v[60:63], v5, s[28:31], 0 offen offset:16
    buffer_load_dwordx4 v[64:67], v5, s[28:31], 0 offen offset:32
    buffer_load_dwordx4 v[68:71], v5, s[28:31], 0 offen offset:48
    buffer_load_dwordx4 v[72:75], v5, s[28:31], 0 offen offset:64
    buffer_load_dwordx4 v[76:79], v5, s[28:31], 0 offen offset:80
    buffer_load_dwordx4 v[80:83], v5, s[28:31], 0 offen offset:96
    buffer_load_dwordx4 v[84:87], v5, s[28:31], 0 offen offset:112
    s_waitcnt vmcnt(0)
    v_lshlrev_b32 v92, 16, v16
    v_and_b32 v93, 0xffff0000, v57
    v_mul_f32 v92, v92, v93
    v_cvt_pk_bf16_f32 v92, v92, v92
    v_lshlrev_b32 v92, 16, v92
    v_mov_b32 v90, v92
    v_lshlrev_b32 v92, 16, v24
    v_lshlrev_b32 v93, 16, v57
    v_mul_f32 v92, v92, v93
    v_cvt_pk_bf16_f32 v92, v92, v92
    v_lshlrev_b32 v92, 16, v92
    v_add_f32 v90, v90, v92
    v_cvt_pk_bf16_f32 v90, v90, v90
    v_lshlrev_b32 v90, 16, v90
    v_lshlrev_b32 v92, 16, v32
    v_and_b32 v93, 0xffff0000, v56
    v_mul_f32 v92, v92, v93
    v_cvt_pk_bf16_f32 v92, v92, v92
    v_lshlrev_b32 v92, 16, v92
    v_add_f32 v90, v90, v92
    v_cvt_pk_bf16_f32 v90, v90, v90
    v_lshlrev_b32 v90, 16, v90
    v_lshlrev_b32 v92, 16, v40
    v_lshlrev_b32 v93, 16, v56
    v_mul_f32 v92, v92, v93
    v_cvt_pk_bf16_f32 v92, v92, v92
    v_lshlrev_b32 v92, 16, v92
    v_add_f32 v90, v90, v92
    v_cvt_pk_bf16_f32 v90, v90, v90
    v_lshlrev_b32 v90, 16, v90
    v_lshlrev_b32 v92, 16, v48
    v_mul_f32 v90, v90, v92
    v_and_b32 v92, 0xffff0000, v16
    v_and_b32 v93, 0xffff0000, v59
    v_mul_f32 v92, v92, v93
    v_cvt_pk_bf16_f32 v92, v92, v92
    v_lshlrev_b32 v92, 16, v92
    v_mov_b32 v91, v92
    v_and_b32 v92, 0xffff0000, v24
    v_lshlrev_b32 v93, 16, v59
    v_mul_f32 v92, v92, v93
    v_cvt_pk_bf16_f32 v92, v92, v92
    v_lshlrev_b32 v92, 16, v92
    v_add_f32 v91, v91, v92
    v_cvt_pk_bf16_f32 v91, v91, v91
    v_lshlrev_b32 v91, 16, v91
    v_and_b32 v92, 0xffff0000, v32
    v_and_b32 v93, 0xffff0000, v58
    v_mul_f32 v92, v92, v93
    v_cvt_pk_bf16_f32 v92, v92, v92
    v_lshlrev_b32 v92, 16, v92
    v_add_f32 v91, v91, v92
    v_cvt_pk_bf16_f32 v91, v91, v91
    v_lshlrev_b32 v91, 16, v91
    v_and_b32 v92, 0xffff0000, v40
    v_lshlrev_b32 v93, 16, v58
    v_mul_f32 v92, v92, v93
    v_cvt_pk_bf16_f32 v92, v92, v92
    v_lshlrev_b32 v92, 16, v92
    v_add_f32 v91, v91, v92
    v_cvt_pk_bf16_f32 v91, v91, v91
    v_lshlrev_b32 v91, 16, v91
    v_and_b32 v92, 0xffff0000, v48
    v_mul_f32 v91, v91, v92
    v_cvt_pk_bf16_f32 v8, v90, v91
    v_lshlrev_b32 v92, 16, v17
    v_and_b32 v93, 0xffff0000, v61
    v_mul_f32 v92, v92, v93
    v_cvt_pk_bf16_f32 v92, v92, v92
    v_lshlrev_b32 v92, 16, v92
    v_mov_b32 v90, v92
    v_lshlrev_b32 v92, 16, v25
    v_lshlrev_b32 v93, 16, v61
    v_mul_f32 v92, v92, v93
    v_cvt_pk_bf16_f32 v92, v92, v92
    v_lshlrev_b32 v92, 16, v92
    v_add_f32 v90, v90, v92
    v_cvt_pk_bf16_f32 v90, v90, v90
    v_lshlrev_b32 v90, 16, v90
    v_lshlrev_b32 v92, 16, v33
    v_and_b32 v93, 0xffff0000, v60
    v_mul_f32 v92, v92, v93
    v_cvt_pk_bf16_f32 v92, v92, v92
    v_lshlrev_b32 v92, 16, v92
    v_add_f32 v90, v90, v92
    v_cvt_pk_bf16_f32 v90, v90, v90
    v_lshlrev_b32 v90, 16, v90
    v_lshlrev_b32 v92, 16, v41
    v_lshlrev_b32 v93, 16, v60
    v_mul_f32 v92, v92, v93
    v_cvt_pk_bf16_f32 v92, v92, v92
    v_lshlrev_b32 v92, 16, v92
    v_add_f32 v90, v90, v92
    v_cvt_pk_bf16_f32 v90, v90, v90
    v_lshlrev_b32 v90, 16, v90
    v_lshlrev_b32 v92, 16, v49
    v_mul_f32 v90, v90, v92
    v_and_b32 v92, 0xffff0000, v17
    v_and_b32 v93, 0xffff0000, v63
    v_mul_f32 v92, v92, v93
    v_cvt_pk_bf16_f32 v92, v92, v92
    v_lshlrev_b32 v92, 16, v92
    v_mov_b32 v91, v92
    v_and_b32 v92, 0xffff0000, v25
    v_lshlrev_b32 v93, 16, v63
    v_mul_f32 v92, v92, v93
    v_cvt_pk_bf16_f32 v92, v92, v92
    v_lshlrev_b32 v92, 16, v92
    v_add_f32 v91, v91, v92
    v_cvt_pk_bf16_f32 v91, v91, v91
    v_lshlrev_b32 v91, 16, v91
    v_and_b32 v92, 0xffff0000, v33
    v_and_b32 v93, 0xffff0000, v62
    v_mul_f32 v92, v92, v93
    v_cvt_pk_bf16_f32 v92, v92, v92
    v_lshlrev_b32 v92, 16, v92
    v_add_f32 v91, v91, v92
    v_cvt_pk_bf16_f32 v91, v91, v91
    v_lshlrev_b32 v91, 16, v91
    v_and_b32 v92, 0xffff0000, v41
    v_lshlrev_b32 v93, 16, v62
    v_mul_f32 v92, v92, v93
    v_cvt_pk_bf16_f32 v92, v92, v92
    v_lshlrev_b32 v92, 16, v92
    v_add_f32 v91, v91, v92
    v_cvt_pk_bf16_f32 v91, v91, v91
    v_lshlrev_b32 v91, 16, v91
    v_and_b32 v92, 0xffff0000, v49
    v_mul_f32 v91, v91, v92
    v_cvt_pk_bf16_f32 v9, v90, v91
    v_lshlrev_b32 v92, 16, v18
    v_and_b32 v93, 0xffff0000, v65
    v_mul_f32 v92, v92, v93
    v_cvt_pk_bf16_f32 v92, v92, v92
    v_lshlrev_b32 v92, 16, v92
    v_mov_b32 v90, v92
    v_lshlrev_b32 v92, 16, v26
    v_lshlrev_b32 v93, 16, v65
    v_mul_f32 v92, v92, v93
    v_cvt_pk_bf16_f32 v92, v92, v92
    v_lshlrev_b32 v92, 16, v92
    v_add_f32 v90, v90, v92
    v_cvt_pk_bf16_f32 v90, v90, v90
    v_lshlrev_b32 v90, 16, v90
    v_lshlrev_b32 v92, 16, v34
    v_and_b32 v93, 0xffff0000, v64
    v_mul_f32 v92, v92, v93
    v_cvt_pk_bf16_f32 v92, v92, v92
    v_lshlrev_b32 v92, 16, v92
    v_add_f32 v90, v90, v92
    v_cvt_pk_bf16_f32 v90, v90, v90
    v_lshlrev_b32 v90, 16, v90
    v_lshlrev_b32 v92, 16, v42
    v_lshlrev_b32 v93, 16, v64
    v_mul_f32 v92, v92, v93
    v_cvt_pk_bf16_f32 v92, v92, v92
    v_lshlrev_b32 v92, 16, v92
    v_add_f32 v90, v90, v92
    v_cvt_pk_bf16_f32 v90, v90, v90
    v_lshlrev_b32 v90, 16, v90
    v_lshlrev_b32 v92, 16, v50
    v_mul_f32 v90, v90, v92
    v_and_b32 v92, 0xffff0000, v18
    v_and_b32 v93, 0xffff0000, v67
    v_mul_f32 v92, v92, v93
    v_cvt_pk_bf16_f32 v92, v92, v92
    v_lshlrev_b32 v92, 16, v92
    v_mov_b32 v91, v92
    v_and_b32 v92, 0xffff0000, v26
    v_lshlrev_b32 v93, 16, v67
    v_mul_f32 v92, v92, v93
    v_cvt_pk_bf16_f32 v92, v92, v92
    v_lshlrev_b32 v92, 16, v92
    v_add_f32 v91, v91, v92
    v_cvt_pk_bf16_f32 v91, v91, v91
    v_lshlrev_b32 v91, 16, v91
    v_and_b32 v92, 0xffff0000, v34
    v_and_b32 v93, 0xffff0000, v66
    v_mul_f32 v92, v92, v93
    v_cvt_pk_bf16_f32 v92, v92, v92
    v_lshlrev_b32 v92, 16, v92
    v_add_f32 v91, v91, v92
    v_cvt_pk_bf16_f32 v91, v91, v91
    v_lshlrev_b32 v91, 16, v91
    v_and_b32 v92, 0xffff0000, v42
    v_lshlrev_b32 v93, 16, v66
    v_mul_f32 v92, v92, v93
    v_cvt_pk_bf16_f32 v92, v92, v92
    v_lshlrev_b32 v92, 16, v92
    v_add_f32 v91, v91, v92
    v_cvt_pk_bf16_f32 v91, v91, v91
    v_lshlrev_b32 v91, 16, v91
    v_and_b32 v92, 0xffff0000, v50
    v_mul_f32 v91, v91, v92
    v_cvt_pk_bf16_f32 v10, v90, v91
    v_lshlrev_b32 v92, 16, v19
    v_and_b32 v93, 0xffff0000, v69
    v_mul_f32 v92, v92, v93
    v_cvt_pk_bf16_f32 v92, v92, v92
    v_lshlrev_b32 v92, 16, v92
    v_mov_b32 v90, v92
    v_lshlrev_b32 v92, 16, v27
    v_lshlrev_b32 v93, 16, v69
    v_mul_f32 v92, v92, v93
    v_cvt_pk_bf16_f32 v92, v92, v92
    v_lshlrev_b32 v92, 16, v92
    v_add_f32 v90, v90, v92
    v_cvt_pk_bf16_f32 v90, v90, v90
    v_lshlrev_b32 v90, 16, v90
    v_lshlrev_b32 v92, 16, v35
    v_and_b32 v93, 0xffff0000, v68
    v_mul_f32 v92, v92, v93
    v_cvt_pk_bf16_f32 v92, v92, v92
    v_lshlrev_b32 v92, 16, v92
    v_add_f32 v90, v90, v92
    v_cvt_pk_bf16_f32 v90, v90, v90
    v_lshlrev_b32 v90, 16, v90
    v_lshlrev_b32 v92, 16, v43
    v_lshlrev_b32 v93, 16, v68
    v_mul_f32 v92, v92, v93
    v_cvt_pk_bf16_f32 v92, v92, v92
    v_lshlrev_b32 v92, 16, v92
    v_add_f32 v90, v90, v92
    v_cvt_pk_bf16_f32 v90, v90, v90
    v_lshlrev_b32 v90, 16, v90
    v_lshlrev_b32 v92, 16, v51
    v_mul_f32 v90, v90, v92
    v_and_b32 v92, 0xffff0000, v19
    v_and_b32 v93, 0xffff0000, v71
    v_mul_f32 v92, v92, v93
    v_cvt_pk_bf16_f32 v92, v92, v92
    v_lshlrev_b32 v92, 16, v92
    v_mov_b32 v91, v92
    v_and_b32 v92, 0xffff0000, v27
    v_lshlrev_b32 v93, 16, v71
    v_mul_f32 v92, v92, v93
    v_cvt_pk_bf16_f32 v92, v92, v92
    v_lshlrev_b32 v92, 16, v92
    v_add_f32 v91, v91, v92
    v_cvt_pk_bf16_f32 v91, v91, v91
    v_lshlrev_b32 v91, 16, v91
    v_and_b32 v92, 0xffff0000, v35
    v_and_b32 v93, 0xffff0000, v70
    v_mul_f32 v92, v92, v93
    v_cvt_pk_bf16_f32 v92, v92, v92
    v_lshlrev_b32 v92, 16, v92
    v_add_f32 v91, v91, v92
    v_cvt_pk_bf16_f32 v91, v91, v91
    v_lshlrev_b32 v91, 16, v91
    v_and_b32 v92, 0xffff0000, v43
    v_lshlrev_b32 v93, 16, v70
    v_mul_f32 v92, v92, v93
    v_cvt_pk_bf16_f32 v92, v92, v92
    v_lshlrev_b32 v92, 16, v92
    v_add_f32 v91, v91, v92
    v_cvt_pk_bf16_f32 v91, v91, v91
    v_lshlrev_b32 v91, 16, v91
    v_and_b32 v92, 0xffff0000, v51
    v_mul_f32 v91, v91, v92
    v_cvt_pk_bf16_f32 v11, v90, v91
    v_lshlrev_b32 v92, 16, v20
    v_and_b32 v93, 0xffff0000, v73
    v_mul_f32 v92, v92, v93
    v_cvt_pk_bf16_f32 v92, v92, v92
    v_lshlrev_b32 v92, 16, v92
    v_mov_b32 v90, v92
    v_lshlrev_b32 v92, 16, v28
    v_lshlrev_b32 v93, 16, v73
    v_mul_f32 v92, v92, v93
    v_cvt_pk_bf16_f32 v92, v92, v92
    v_lshlrev_b32 v92, 16, v92
    v_add_f32 v90, v90, v92
    v_cvt_pk_bf16_f32 v90, v90, v90
    v_lshlrev_b32 v90, 16, v90
    v_lshlrev_b32 v92, 16, v36
    v_and_b32 v93, 0xffff0000, v72
    v_mul_f32 v92, v92, v93
    v_cvt_pk_bf16_f32 v92, v92, v92
    v_lshlrev_b32 v92, 16, v92
    v_add_f32 v90, v90, v92
    v_cvt_pk_bf16_f32 v90, v90, v90
    v_lshlrev_b32 v90, 16, v90
    v_lshlrev_b32 v92, 16, v44
    v_lshlrev_b32 v93, 16, v72
    v_mul_f32 v92, v92, v93
    v_cvt_pk_bf16_f32 v92, v92, v92
    v_lshlrev_b32 v92, 16, v92
    v_add_f32 v90, v90, v92
    v_cvt_pk_bf16_f32 v90, v90, v90
    v_lshlrev_b32 v90, 16, v90
    v_lshlrev_b32 v92, 16, v52
    v_mul_f32 v90, v90, v92
    v_and_b32 v92, 0xffff0000, v20
    v_and_b32 v93, 0xffff0000, v75
    v_mul_f32 v92, v92, v93
    v_cvt_pk_bf16_f32 v92, v92, v92
    v_lshlrev_b32 v92, 16, v92
    v_mov_b32 v91, v92
    v_and_b32 v92, 0xffff0000, v28
    v_lshlrev_b32 v93, 16, v75
    v_mul_f32 v92, v92, v93
    v_cvt_pk_bf16_f32 v92, v92, v92
    v_lshlrev_b32 v92, 16, v92
    v_add_f32 v91, v91, v92
    v_cvt_pk_bf16_f32 v91, v91, v91
    v_lshlrev_b32 v91, 16, v91
    v_and_b32 v92, 0xffff0000, v36
    v_and_b32 v93, 0xffff0000, v74
    v_mul_f32 v92, v92, v93
    v_cvt_pk_bf16_f32 v92, v92, v92
    v_lshlrev_b32 v92, 16, v92
    v_add_f32 v91, v91, v92
    v_cvt_pk_bf16_f32 v91, v91, v91
    v_lshlrev_b32 v91, 16, v91
    v_and_b32 v92, 0xffff0000, v44
    v_lshlrev_b32 v93, 16, v74
    v_mul_f32 v92, v92, v93
    v_cvt_pk_bf16_f32 v92, v92, v92
    v_lshlrev_b32 v92, 16, v92
    v_add_f32 v91, v91, v92
    v_cvt_pk_bf16_f32 v91, v91, v91
    v_lshlrev_b32 v91, 16, v91
    v_and_b32 v92, 0xffff0000, v52
    v_mul_f32 v91, v91, v92
    v_cvt_pk_bf16_f32 v12, v90, v91
    v_lshlrev_b32 v92, 16, v21
    v_and_b32 v93, 0xffff0000, v77
    v_mul_f32 v92, v92, v93
    v_cvt_pk_bf16_f32 v92, v92, v92
    v_lshlrev_b32 v92, 16, v92
    v_mov_b32 v90, v92
    v_lshlrev_b32 v92, 16, v29
    v_lshlrev_b32 v93, 16, v77
    v_mul_f32 v92, v92, v93
    v_cvt_pk_bf16_f32 v92, v92, v92
    v_lshlrev_b32 v92, 16, v92
    v_add_f32 v90, v90, v92
    v_cvt_pk_bf16_f32 v90, v90, v90
    v_lshlrev_b32 v90, 16, v90
    v_lshlrev_b32 v92, 16, v37
    v_and_b32 v93, 0xffff0000, v76
    v_mul_f32 v92, v92, v93
    v_cvt_pk_bf16_f32 v92, v92, v92
    v_lshlrev_b32 v92, 16, v92
    v_add_f32 v90, v90, v92
    v_cvt_pk_bf16_f32 v90, v90, v90
    v_lshlrev_b32 v90, 16, v90
    v_lshlrev_b32 v92, 16, v45
    v_lshlrev_b32 v93, 16, v76
    v_mul_f32 v92, v92, v93
    v_cvt_pk_bf16_f32 v92, v92, v92
    v_lshlrev_b32 v92, 16, v92
    v_add_f32 v90, v90, v92
    v_cvt_pk_bf16_f32 v90, v90, v90
    v_lshlrev_b32 v90, 16, v90
    v_lshlrev_b32 v92, 16, v53
    v_mul_f32 v90, v90, v92
    v_and_b32 v92, 0xffff0000, v21
    v_and_b32 v93, 0xffff0000, v79
    v_mul_f32 v92, v92, v93
    v_cvt_pk_bf16_f32 v92, v92, v92
    v_lshlrev_b32 v92, 16, v92
    v_mov_b32 v91, v92
    v_and_b32 v92, 0xffff0000, v29
    v_lshlrev_b32 v93, 16, v79
    v_mul_f32 v92, v92, v93
    v_cvt_pk_bf16_f32 v92, v92, v92
    v_lshlrev_b32 v92, 16, v92
    v_add_f32 v91, v91, v92
    v_cvt_pk_bf16_f32 v91, v91, v91
    v_lshlrev_b32 v91, 16, v91
    v_and_b32 v92, 0xffff0000, v37
    v_and_b32 v93, 0xffff0000, v78
    v_mul_f32 v92, v92, v93
    v_cvt_pk_bf16_f32 v92, v92, v92
    v_lshlrev_b32 v92, 16, v92
    v_add_f32 v91, v91, v92
    v_cvt_pk_bf16_f32 v91, v91, v91
    v_lshlrev_b32 v91, 16, v91
    v_and_b32 v92, 0xffff0000, v45
    v_lshlrev_b32 v93, 16, v78
    v_mul_f32 v92, v92, v93
    v_cvt_pk_bf16_f32 v92, v92, v92
    v_lshlrev_b32 v92, 16, v92
    v_add_f32 v91, v91, v92
    v_cvt_pk_bf16_f32 v91, v91, v91
    v_lshlrev_b32 v91, 16, v91
    v_and_b32 v92, 0xffff0000, v53
    v_mul_f32 v91, v91, v92
    v_cvt_pk_bf16_f32 v13, v90, v91
    v_lshlrev_b32 v92, 16, v22
    v_and_b32 v93, 0xffff0000, v81
    v_mul_f32 v92, v92, v93
    v_cvt_pk_bf16_f32 v92, v92, v92
    v_lshlrev_b32 v92, 16, v92
    v_mov_b32 v90, v92
    v_lshlrev_b32 v92, 16, v30
    v_lshlrev_b32 v93, 16, v81
    v_mul_f32 v92, v92, v93
    v_cvt_pk_bf16_f32 v92, v92, v92
    v_lshlrev_b32 v92, 16, v92
    v_add_f32 v90, v90, v92
    v_cvt_pk_bf16_f32 v90, v90, v90
    v_lshlrev_b32 v90, 16, v90
    v_lshlrev_b32 v92, 16, v38
    v_and_b32 v93, 0xffff0000, v80
    v_mul_f32 v92, v92, v93
    v_cvt_pk_bf16_f32 v92, v92, v92
    v_lshlrev_b32 v92, 16, v92
    v_add_f32 v90, v90, v92
    v_cvt_pk_bf16_f32 v90, v90, v90
    v_lshlrev_b32 v90, 16, v90
    v_lshlrev_b32 v92, 16, v46
    v_lshlrev_b32 v93, 16, v80
    v_mul_f32 v92, v92, v93
    v_cvt_pk_bf16_f32 v92, v92, v92
    v_lshlrev_b32 v92, 16, v92
    v_add_f32 v90, v90, v92
    v_cvt_pk_bf16_f32 v90, v90, v90
    v_lshlrev_b32 v90, 16, v90
    v_lshlrev_b32 v92, 16, v54
    v_mul_f32 v90, v90, v92
    v_and_b32 v92, 0xffff0000, v22
    v_and_b32 v93, 0xffff0000, v83
    v_mul_f32 v92, v92, v93
    v_cvt_pk_bf16_f32 v92, v92, v92
    v_lshlrev_b32 v92, 16, v92
    v_mov_b32 v91, v92
    v_and_b32 v92, 0xffff0000, v30
    v_lshlrev_b32 v93, 16, v83
    v_mul_f32 v92, v92, v93
    v_cvt_pk_bf16_f32 v92, v92, v92
    v_lshlrev_b32 v92, 16, v92
    v_add_f32 v91, v91, v92
    v_cvt_pk_bf16_f32 v91, v91, v91
    v_lshlrev_b32 v91, 16, v91
    v_and_b32 v92, 0xffff0000, v38
    v_and_b32 v93, 0xffff0000, v82
    v_mul_f32 v92, v92, v93
    v_cvt_pk_bf16_f32 v92, v92, v92
    v_lshlrev_b32 v92, 16, v92
    v_add_f32 v91, v91, v92
    v_cvt_pk_bf16_f32 v91, v91, v91
    v_lshlrev_b32 v91, 16, v91
    v_and_b32 v92, 0xffff0000, v46
    v_lshlrev_b32 v93, 16, v82
    v_mul_f32 v92, v92, v93
    v_cvt_pk_bf16_f32 v92, v92, v92
    v_lshlrev_b32 v92, 16, v92
    v_add_f32 v91, v91, v92
    v_cvt_pk_bf16_f32 v91, v91, v91
    v_lshlrev_b32 v91, 16, v91
    v_and_b32 v92, 0xffff0000, v54
    v_mul_f32 v91, v91, v92
    v_cvt_pk_bf16_f32 v14, v90, v91
    v_lshlrev_b32 v92, 16, v23
    v_and_b32 v93, 0xffff0000, v85
    v_mul_f32 v92, v92, v93
    v_cvt_pk_bf16_f32 v92, v92, v92
    v_lshlrev_b32 v92, 16, v92
    v_mov_b32 v90, v92
    v_lshlrev_b32 v92, 16, v31
    v_lshlrev_b32 v93, 16, v85
    v_mul_f32 v92, v92, v93
    v_cvt_pk_bf16_f32 v92, v92, v92
    v_lshlrev_b32 v92, 16, v92
    v_add_f32 v90, v90, v92
    v_cvt_pk_bf16_f32 v90, v90, v90
    v_lshlrev_b32 v90, 16, v90
    v_lshlrev_b32 v92, 16, v39
    v_and_b32 v93, 0xffff0000, v84
    v_mul_f32 v92, v92, v93
    v_cvt_pk_bf16_f32 v92, v92, v92
    v_lshlrev_b32 v92, 16, v92
    v_add_f32 v90, v90, v92
    v_cvt_pk_bf16_f32 v90, v90, v90
    v_lshlrev_b32 v90, 16, v90
    v_lshlrev_b32 v92, 16, v47
    v_lshlrev_b32 v93, 16, v84
    v_mul_f32 v92, v92, v93
    v_cvt_pk_bf16_f32 v92, v92, v92
    v_lshlrev_b32 v92, 16, v92
    v_add_f32 v90, v90, v92
    v_cvt_pk_bf16_f32 v90, v90, v90
    v_lshlrev_b32 v90, 16, v90
    v_lshlrev_b32 v92, 16, v55
    v_mul_f32 v90, v90, v92
    v_and_b32 v92, 0xffff0000, v23
    v_and_b32 v93, 0xffff0000, v87
    v_mul_f32 v92, v92, v93
    v_cvt_pk_bf16_f32 v92, v92, v92
    v_lshlrev_b32 v92, 16, v92
    v_mov_b32 v91, v92
    v_and_b32 v92, 0xffff0000, v31
    v_lshlrev_b32 v93, 16, v87
    v_mul_f32 v92, v92, v93
    v_cvt_pk_bf16_f32 v92, v92, v92
    v_lshlrev_b32 v92, 16, v92
    v_add_f32 v91, v91, v92
    v_cvt_pk_bf16_f32 v91, v91, v91
    v_lshlrev_b32 v91, 16, v91
    v_and_b32 v92, 0xffff0000, v39
    v_and_b32 v93, 0xffff0000, v86
    v_mul_f32 v92, v92, v93
    v_cvt_pk_bf16_f32 v92, v92, v92
    v_lshlrev_b32 v92, 16, v92
    v_add_f32 v91, v91, v92
    v_cvt_pk_bf16_f32 v91, v91, v91
    v_lshlrev_b32 v91, 16, v91
    v_and_b32 v92, 0xffff0000, v47
    v_lshlrev_b32 v93, 16, v86
    v_mul_f32 v92, v92, v93
    v_cvt_pk_bf16_f32 v92, v92, v92
    v_lshlrev_b32 v92, 16, v92
    v_add_f32 v91, v91, v92
    v_cvt_pk_bf16_f32 v91, v91, v91
    v_lshlrev_b32 v91, 16, v91
    v_and_b32 v92, 0xffff0000, v55
    v_mul_f32 v91, v91, v92
    v_cvt_pk_bf16_f32 v15, v90, v91
prep_tr:
    v_mul_u32_u24 v5, 2176, v2
    v_lshl_add_u32 v5, v1, 1, v5
    ds_write_b16 v5, v8 offset:0
    ds_write_b16_d16_hi v5, v8 offset:136
    ds_write_b16 v5, v9 offset:272
    ds_write_b16_d16_hi v5, v9 offset:408
    ds_write_b16 v5, v10 offset:544
    ds_write_b16_d16_hi v5, v10 offset:680
    ds_write_b16 v5, v11 offset:816
    ds_write_b16_d16_hi v5, v11 offset:952
    ds_write_b16 v5, v12 offset:1088
    ds_write_b16_d16_hi v5, v12 offset:1224
    ds_write_b16 v5, v13 offset:1360
    ds_write_b16_d16_hi v5, v13 offset:1496
    ds_write_b16 v5, v14 offset:1632
    ds_write_b16_d16_hi v5, v14 offset:1768
    ds_write_b16 v5, v15 offset:1904
    ds_write_b16_d16_hi v5, v15 offset:2040
    s_waitcnt lgkmcnt(0)
    s_barrier
    v_mul_u32_u24 v5, 136, v1
    v_lshl_add_u32 v5, v2, 5, v5
    ds_read_b64 v[8:9], v5 offset:0
    ds_read_b64 v[10:11], v5 offset:8
    ds_read_b64 v[12:13], v5 offset:16
    ds_read_b64 v[14:15], v5 offset:24
    v_mul_lo_u32 v3, v1, s21
    v_lshl_add_u32 v3, v2, 5, v3
    v_add_u32 v3, s10, v3
    s_waitcnt lgkmcnt(0)
    buffer_store_dwordx4 v[8:11], v3, s[16:19], 0 offen
    buffer_store_dwordx4 v[12:15], v3, s[16:19], 0 offen offset:16
prep_end:
    s_endpgm
.globl conv_kernel
.p2align 8
.type conv_kernel,@function
conv_kernel:
    s_load_dwordx16 s[36:51], s[0:1], 0
    s_load_dwordx8 s[52:59], s[0:1], 64
    s_load_dwordx2 s[60:61], s[0:1], 104
    s_load_dwordx2 s[62:63], s[0:1], 120
    s_waitcnt lgkmcnt(0)
    s_cmp_ge_u32 s2, 224
    s_cbranch_scc1 conv_end
    v_mov_b32 v4, 0
    v_mov_b32 v5, 0
    v_mov_b32 v6, 0
    v_mov_b32 v7, 0
    v_lshlrev_b32 v1, 4, v0
    ds_write_b128 v1, v[4:7] offset:0
    ds_write_b128 v1, v[4:7] offset:4096
    ds_write_b128 v1, v[4:7] offset:8192
    ds_write_b128 v1, v[4:7] offset:12288
    ds_write_b128 v1, v[4:7] offset:16384
    ds_write_b128 v1, v[4:7] offset:20480
    ds_write_b128 v1, v[4:7] offset:24576
    ds_write_b128 v1, v[4:7] offset:28672
    ds_write_b128 v1, v[4:7] offset:32768
    ds_write_b128 v1, v[4:7] offset:36864
    ds_write_b128 v1, v[4:7] offset:40960
    s_mov_b32 s12, s44
    s_mov_b32 s13, s45
    s_mov_b32 s14, 1835008
    s_mov_b32 s15, 0x20000
    s_add_u32 s16, s62, 0
    s_addc_u32 s17, s63, 0
    s_mov_b32 s18, 1835008
    s_mov_b32 s19, 0x20000
    s_add_u32 s20, s62, 2097152
    s_addc_u32 s21, s63, 0
    s_mov_b32 s22, 1835008
    s_mov_b32 s23, 0x20000
    s_mov_b32 s24, s46
    s_mov_b32 s25, s47
    s_mov_b32 s26, 896
    s_mov_b32 s27, 0x20000
    v_lshrrev_b32 v2, 7, v0
    v_and_b32 v3, 127, v0
    s_lshl_b32 s4, s2, 13
    v_lshlrev_b32 v8, 12, v2
    v_lshl_add_u32 v8, v3, 5, v8
    v_add_u32 v8, s4, v8
    buffer_load_dwordx4 v[16:19], v8, s[12:15], 0 offen
    buffer_load_dwordx4 v[20:23], v8, s[12:15], 0 offen offset:16
    buffer_load_dwordx4 v[24:27], v8, s[16:19], 0 offen
    buffer_load_dwordx4 v[28:31], v8, s[16:19], 0 offen offset:16
    s_lshl_b32 s5, s2, 2
    v_lshl_add_u32 v9, v2, 1, s5
    buffer_load_ushort v60, v9, s[24:27], 0 offen
    v_mul_u32_u24 v10, 21504, v2
    v_lshlrev_b32 v11, 5, v3
    v_sub_u32 v11, v10, v11
    v_add_u32 v11, 4192, v11
    s_waitcnt lgkmcnt(0)
    s_barrier
    s_waitcnt vmcnt(0)
    ds_write_b16 v11, v16 offset:30
    ds_write_b16 v11, v16 offset:4636
    ds_write_b16_d16_hi v11, v16 offset:28
    ds_write_b16_d16_hi v11, v16 offset:4634
    ds_write_b16 v11, v17 offset:26
    ds_write_b16 v11, v17 offset:4632
    ds_write_b16_d16_hi v11, v17 offset:24
    ds_write_b16_d16_hi v11, v17 offset:4630
    ds_write_b16 v11, v18 offset:22
    ds_write_b16 v11, v18 offset:4628
    ds_write_b16_d16_hi v11, v18 offset:20
    ds_write_b16_d16_hi v11, v18 offset:4626
    ds_write_b16 v11, v19 offset:18
    ds_write_b16 v11, v19 offset:4624
    ds_write_b16_d16_hi v11, v19 offset:16
    ds_write_b16_d16_hi v11, v19 offset:4622
    ds_write_b16 v11, v20 offset:14
    ds_write_b16 v11, v20 offset:4620
    ds_write_b16_d16_hi v11, v20 offset:12
    ds_write_b16_d16_hi v11, v20 offset:4618
    ds_write_b16 v11, v21 offset:10
    ds_write_b16 v11, v21 offset:4616
    ds_write_b16_d16_hi v11, v21 offset:8
    ds_write_b16_d16_hi v11, v21 offset:4614
    ds_write_b16 v11, v22 offset:6
    ds_write_b16 v11, v22 offset:4612
    ds_write_b16_d16_hi v11, v22 offset:4
    ds_write_b16_d16_hi v11, v22 offset:4610
    ds_write_b16 v11, v23 offset:2
    ds_write_b16 v11, v23 offset:4608
    ds_write_b16_d16_hi v11, v23 offset:0
    ds_write_b16_d16_hi v11, v23 offset:4606
    v_lshl_add_u32 v12, v3, 5, v10
    ds_write_b128 v12, v[24:27] offset:13184
    ds_write_b128 v12, v[28:31] offset:13200
    v_and_b32 v13, 31, v0
    v_bfe_u32 v14, v0, 5, 1
    v_bfe_u32 v15, v0, 6, 1
    v_lshl_add_u32 v48, v15, 5, v13
    v_lshlrev_b32 v49, 3, v14
    v_sub_u32 v49, v49, v48
    v_add_u32 v49, 2111, v49
    v_and_b32 v50, 1, v49
    v_mul_u32_u24 v50, 4606, v50
    v_lshl_add_u32 v50, v49, 1, v50
    v_add_u32 v50, v50, v10
    v_lshlrev_b32 v51, 7, v13
    v_lshl_add_u32 v51, v14, 4, v51
    v_add_u32 v51, v51, v10
    v_add_u32 v51, 13184, v51
    v_mov_b32 v32, 0
    v_mov_b32 v33, 0
    v_mov_b32 v34, 0
    v_mov_b32 v35, 0
    v_mov_b32 v36, 0
    v_mov_b32 v37, 0
    v_mov_b32 v38, 0
    v_mov_b32 v39, 0
    v_mov_b32 v40, 0
    v_mov_b32 v41, 0
    v_mov_b32 v42, 0
    v_mov_b32 v43, 0
    v_mov_b32 v44, 0
    v_mov_b32 v45, 0
    v_mov_b32 v46, 0
    v_mov_b32 v47, 0
    s_waitcnt lgkmcnt(0)
    s_barrier
    s_mov_b32 s6, 0
conv_loop:
    ds_read2_b32 v[64:65], v50 offset0:0 offset1:1
    ds_read2_b32 v[66:67], v50 offset0:2 offset1:3
    ds_read_b128 v[68:71], v51 offset:0
    ds_read2_b32 v[72:73], v50 offset0:8 offset1:9
    ds_read2_b32 v[74:75], v50 offset0:10 offset1:11
    ds_read_b128 v[76:79], v51 offset:32
    ds_read2_b32 v[80:81], v50 offset0:16 offset1:17
    ds_read2_b32 v[82:83], v50 offset0:18 offset1:19
    ds_read_b128 v[84:87], v51 offset:64
    ds_read2_b32 v[88:89], v50 offset0:24 offset1:25
    ds_read2_b32 v[90:91], v50 offset0:26 offset1:27
    ds_read_b128 v[92:95], v51 offset:96
    v_subrev_u32 v50, 128, v50
    v_subrev_u32 v51, 128, v51
    s_waitcnt lgkmcnt(9)
    v_mfma_f32_32x32x16_bf16 v[32:47], v[64:67], v[68:71], v[32:47]
    s_waitcnt lgkmcnt(6)
    v_mfma_f32_32x32x16_bf16 v[32:47], v[72:75], v[76:79], v[32:47]
    s_waitcnt lgkmcnt(3)
    v_mfma_f32_32x32x16_bf16 v[32:47], v[80:83], v[84:87], v[32:47]
    s_waitcnt lgkmcnt(0)
    v_mfma_f32_32x32x16_bf16 v[32:47], v[88:91], v[92:95], v[32:47]
    s_add_u32 s6, s6, 1
    s_cmp_lt_u32 s6, 32
    s_cbranch_scc1 conv_loop
    s_nop 15
    v_lshlrev_b32 v52, 7, v13
    v_lshl_add_u32 v52, v15, 6, v52
    v_lshl_add_u32 v52, v14, 3, v52
    v_add_u32 v52, v52, v10
    v_cvt_pk_bf16_f32 v53, v32, v33
    ds_write_b32 v52, v53 offset:17408
    s_nop 1
    v_cvt_pk_bf16_f32 v53, v34, v35
    ds_write_b32 v52, v53 offset:17412
    s_nop 1
    v_cvt_pk_bf16_f32 v53, v36, v37
    ds_write_b32 v52, v53 offset:17424
    s_nop 1
    v_cvt_pk_bf16_f32 v53, v38, v39
    ds_write_b32 v52, v53 offset:17428
    s_nop 1
    v_cvt_pk_bf16_f32 v53, v40, v41
    ds_write_b32 v52, v53 offset:17440
    s_nop 1
    v_cvt_pk_bf16_f32 v53, v42, v43
    ds_write_b32 v52, v53 offset:17444
    s_nop 1
    v_cvt_pk_bf16_f32 v53, v44, v45
    ds_write_b32 v52, v53 offset:17456
    s_nop 1
    v_cvt_pk_bf16_f32 v53, v46, v47
    ds_write_b32 v52, v53 offset:17460
    s_nop 1
    s_waitcnt lgkmcnt(0)
    s_barrier
    ds_read_b128 v[16:19], v12 offset:17408
    ds_read_b128 v[20:23], v12 offset:17424
    v_lshlrev_b32 v60, 16, v60
    s_waitcnt lgkmcnt(0)
    v_lshlrev_b32 v61, 16, v24
    v_and_b32 v62, 0xffff0000, v24
    v_lshlrev_b32 v63, 16, v16
    v_and_b32 v64, 0xffff0000, v16
    v_mul_f32 v61, v61, v60
    v_mul_f32 v62, v62, v60
    v_cvt_pk_bf16_f32 v61, v61, v61
    v_lshlrev_b32 v61, 16, v61
    v_cvt_pk_bf16_f32 v62, v62, v62
    v_lshlrev_b32 v62, 16, v62
    v_add_f32 v61, v61, v63
    v_add_f32 v62, v62, v64
    v_cvt_pk_bf16_f32 v16, v61, v62
    v_lshlrev_b32 v61, 16, v25
    v_and_b32 v62, 0xffff0000, v25
    v_lshlrev_b32 v63, 16, v17
    v_and_b32 v64, 0xffff0000, v17
    v_mul_f32 v61, v61, v60
    v_mul_f32 v62, v62, v60
    v_cvt_pk_bf16_f32 v61, v61, v61
    v_lshlrev_b32 v61, 16, v61
    v_cvt_pk_bf16_f32 v62, v62, v62
    v_lshlrev_b32 v62, 16, v62
    v_add_f32 v61, v61, v63
    v_add_f32 v62, v62, v64
    v_cvt_pk_bf16_f32 v17, v61, v62
    v_lshlrev_b32 v61, 16, v26
    v_and_b32 v62, 0xffff0000, v26
    v_lshlrev_b32 v63, 16, v18
    v_and_b32 v64, 0xffff0000, v18
    v_mul_f32 v61, v61, v60
    v_mul_f32 v62, v62, v60
    v_cvt_pk_bf16_f32 v61, v61, v61
    v_lshlrev_b32 v61, 16, v61
    v_cvt_pk_bf16_f32 v62, v62, v62
    v_lshlrev_b32 v62, 16, v62
    v_add_f32 v61, v61, v63
    v_add_f32 v62, v62, v64
    v_cvt_pk_bf16_f32 v18, v61, v62
    v_lshlrev_b32 v61, 16, v27
    v_and_b32 v62, 0xffff0000, v27
    v_lshlrev_b32 v63, 16, v19
    v_and_b32 v64, 0xffff0000, v19
    v_mul_f32 v61, v61, v60
    v_mul_f32 v62, v62, v60
    v_cvt_pk_bf16_f32 v61, v61, v61
    v_lshlrev_b32 v61, 16, v61
    v_cvt_pk_bf16_f32 v62, v62, v62
    v_lshlrev_b32 v62, 16, v62
    v_add_f32 v61, v61, v63
    v_add_f32 v62, v62, v64
    v_cvt_pk_bf16_f32 v19, v61, v62
    v_lshlrev_b32 v61, 16, v28
    v_and_b32 v62, 0xffff0000, v28
    v_lshlrev_b32 v63, 16, v20
    v_and_b32 v64, 0xffff0000, v20
    v_mul_f32 v61, v61, v60
    v_mul_f32 v62, v62, v60
    v_cvt_pk_bf16_f32 v61, v61, v61
    v_lshlrev_b32 v61, 16, v61
    v_cvt_pk_bf16_f32 v62, v62, v62
    v_lshlrev_b32 v62, 16, v62
    v_add_f32 v61, v61, v63
    v_add_f32 v62, v62, v64
    v_cvt_pk_bf16_f32 v20, v61, v62
    v_lshlrev_b32 v61, 16, v29
    v_and_b32 v62, 0xffff0000, v29
    v_lshlrev_b32 v63, 16, v21
    v_and_b32 v64, 0xffff0000, v21
    v_mul_f32 v61, v61, v60
    v_mul_f32 v62, v62, v60
    v_cvt_pk_bf16_f32 v61, v61, v61
    v_lshlrev_b32 v61, 16, v61
    v_cvt_pk_bf16_f32 v62, v62, v62
    v_lshlrev_b32 v62, 16, v62
    v_add_f32 v61, v61, v63
    v_add_f32 v62, v62, v64
    v_cvt_pk_bf16_f32 v21, v61, v62
    v_lshlrev_b32 v61, 16, v30
    v_and_b32 v62, 0xffff0000, v30
    v_lshlrev_b32 v63, 16, v22
    v_and_b32 v64, 0xffff0000, v22
    v_mul_f32 v61, v61, v60
    v_mul_f32 v62, v62, v60
    v_cvt_pk_bf16_f32 v61, v61, v61
    v_lshlrev_b32 v61, 16, v61
    v_cvt_pk_bf16_f32 v62, v62, v62
    v_lshlrev_b32 v62, 16, v62
    v_add_f32 v61, v61, v63
    v_add_f32 v62, v62, v64
    v_cvt_pk_bf16_f32 v22, v61, v62
    v_lshlrev_b32 v61, 16, v31
    v_and_b32 v62, 0xffff0000, v31
    v_lshlrev_b32 v63, 16, v23
    v_and_b32 v64, 0xffff0000, v23
    v_mul_f32 v61, v61, v60
    v_mul_f32 v62, v62, v60
    v_cvt_pk_bf16_f32 v61, v61, v61
    v_lshlrev_b32 v61, 16, v61
    v_cvt_pk_bf16_f32 v62, v62, v62
    v_lshlrev_b32 v62, 16, v62
    v_add_f32 v61, v61, v63
    v_add_f32 v62, v62, v64
    v_cvt_pk_bf16_f32 v23, v61, v62
    buffer_store_dwordx4 v[16:19], v8, s[20:23], 0 offen
    buffer_store_dwordx4 v[20:23], v8, s[20:23], 0 offen offset:16
conv_end:
    s_endpgm
.globl row0_kernel
.p2align 8
.type row0_kernel,@function
row0_kernel:
    s_load_dwordx16 s[36:51], s[0:1], 0
    s_load_dwordx8 s[52:59], s[0:1], 64
    s_load_dwordx2 s[60:61], s[0:1], 104
    s_load_dwordx2 s[62:63], s[0:1], 120
    s_waitcnt lgkmcnt(0)
    s_cmp_ge_u32 s2, 64
    s_cbranch_scc1 row0_end
    s_mov_b32 s12, s36
    s_mov_b32 s13, s37
    s_mov_b32 s14, 1835008
    s_mov_b32 s15, 0x20000
    s_add_u32 s16, s62, 2097152
    s_addc_u32 s17, s63, 0
    s_mov_b32 s18, 1835008
    s_mov_b32 s19, 0x20000
    s_add_u32 s20, s62, 4194304
    s_addc_u32 s21, s63, 0
    s_mov_b32 s22, 1835008
    s_mov_b32 s23, 0x20000
    s_add_u32 s24, s62, 6291456
    s_addc_u32 s25, s63, 0
    s_mov_b32 s26, 1835008
    s_mov_b32 s27, 0x20000
    v_lshrrev_b32 v1, 2, v0
    v_and_b32 v2, 3, v0
    s_lshl_b32 s4, s2, 6
    v_lshlrev_b32 v3, 12, v1
    v_lshl_add_u32 v3, v2, 4, v3
    v_add_u32 v3, s4, v3
    buffer_load_dwordx4 v[8:11], v3, s[16:19], 0 offen offset:0
    v_add_u32 v3, 0x40000, v3
    buffer_load_dwordx4 v[12:15], v3, s[16:19], 0 offen offset:0
    v_add_u32 v3, 0x40000, v3
    buffer_load_dwordx4 v[16:19], v3, s[16:19], 0 offen offset:0
    v_add_u32 v3, 0x40000, v3
    buffer_load_dwordx4 v[20:23], v3, s[16:19], 0 offen offset:0
    v_add_u32 v3, 0x40000, v3
    buffer_load_dwordx4 v[24:27], v3, s[16:19], 0 offen offset:0
    v_add_u32 v3, 0x40000, v3
    buffer_load_dwordx4 v[28:31], v3, s[16:19], 0 offen offset:0
    v_add_u32 v3, 0x40000, v3
    buffer_load_dwordx4 v[32:35], v3, s[16:19], 0 offen offset:0
    v_add_u32 v3, 0x40000, v3
    v_mul_u32_u24 v4, 7296, v2
    v_lshl_add_u32 v4, v1, 1, v4
    s_waitcnt vmcnt(0)
    ds_write_b16 v4, v8 offset:0
    ds_write_b16_d16_hi v4, v8 offset:912
    ds_write_b16 v4, v9 offset:1824
    ds_write_b16_d16_hi v4, v9 offset:2736
    ds_write_b16 v4, v10 offset:3648
    ds_write_b16_d16_hi v4, v10 offset:4560
    ds_write_b16 v4, v11 offset:5472
    ds_write_b16_d16_hi v4, v11 offset:6384
    ds_write_b16 v4, v12 offset:128
    ds_write_b16_d16_hi v4, v12 offset:1040
    ds_write_b16 v4, v13 offset:1952
    ds_write_b16_d16_hi v4, v13 offset:2864
    ds_write_b16 v4, v14 offset:3776
    ds_write_b16_d16_hi v4, v14 offset:4688
    ds_write_b16 v4, v15 offset:5600
    ds_write_b16_d16_hi v4, v15 offset:6512
    ds_write_b16 v4, v16 offset:256
    ds_write_b16_d16_hi v4, v16 offset:1168
    ds_write_b16 v4, v17 offset:2080
    ds_write_b16_d16_hi v4, v17 offset:2992
    ds_write_b16 v4, v18 offset:3904
    ds_write_b16_d16_hi v4, v18 offset:4816
    ds_write_b16 v4, v19 offset:5728
    ds_write_b16_d16_hi v4, v19 offset:6640
    ds_write_b16 v4, v20 offset:384
    ds_write_b16_d16_hi v4, v20 offset:1296
    ds_write_b16 v4, v21 offset:2208
    ds_write_b16_d16_hi v4, v21 offset:3120
    ds_write_b16 v4, v22 offset:4032
    ds_write_b16_d16_hi v4, v22 offset:4944
    ds_write_b16 v4, v23 offset:5856
    ds_write_b16_d16_hi v4, v23 offset:6768
    ds_write_b16 v4, v24 offset:512
    ds_write_b16_d16_hi v4, v24 offset:1424
    ds_write_b16 v4, v25 offset:2336
    ds_write_b16_d16_hi v4, v25 offset:3248
    ds_write_b16 v4, v26 offset:4160
    ds_write_b16_d16_hi v4, v26 offset:5072
    ds_write_b16 v4, v27 offset:5984
    ds_write_b16_d16_hi v4, v27 offset:6896
    ds_write_b16 v4, v28 offset:640
    ds_write_b16_d16_hi v4, v28 offset:1552
    ds_write_b16 v4, v29 offset:2464
    ds_write_b16_d16_hi v4, v29 offset:3376
    ds_write_b16 v4, v30 offset:4288
    ds_write_b16_d16_hi v4, v30 offset:5200
    ds_write_b16 v4, v31 offset:6112
    ds_write_b16_d16_hi v4, v31 offset:7024
    ds_write_b16 v4, v32 offset:768
    ds_write_b16_d16_hi v4, v32 offset:1680
    ds_write_b16 v4, v33 offset:2592
    ds_write_b16_d16_hi v4, v33 offset:3504
    ds_write_b16 v4, v34 offset:4416
    ds_write_b16_d16_hi v4, v34 offset:5328
    ds_write_b16 v4, v35 offset:6240
    ds_write_b16_d16_hi v4, v35 offset:7152
    v_and_b32 v5, 63, v0
    v_lshrrev_b32 v6, 6, v0
    v_xor_b32 v100, 1, v5
    v_lshlrev_b32 v100, 2, v100
    v_xor_b32 v101, 2, v5
    v_lshlrev_b32 v101, 2, v101
    v_xor_b32 v102, 4, v5
    v_lshlrev_b32 v102, 2, v102
    v_xor_b32 v103, 8, v5
    v_lshlrev_b32 v103, 2, v103
    v_xor_b32 v104, 16, v5
    v_lshlrev_b32 v104, 2, v104
    v_xor_b32 v105, 32, v5
    v_lshlrev_b32 v105, 2, v105
    v_cmp_gt_u32 vcc, 56, v5
    v_mov_b32 v98, 0
    s_nop 1
    v_cndmask_b32 v98, v98, 1.0, vcc
    v_mul_u32_u24 v7, 7296, v6
    v_lshl_add_u32 v7, v5, 4, v7
    v_mul_u32_u24 v40, 7168, v6
    v_lshl_add_u32 v40, v5, 4, v40
    s_mul_i32 s5, s2, 28672
    v_add_u32 v40, s5, v40
    s_waitcnt lgkmcnt(0)
    s_barrier
    s_and_saveexec_b64 s[30:31], vcc
    s_mov_b32 s6, 0
row0_loop:
    buffer_load_dwordx4 v[8:11], v40, s[12:15], 0 offen
    ds_read_b128 v[12:15], v7
    s_waitcnt vmcnt(0) lgkmcnt(0)
    s_or_b64 exec, exec, s[30:31]
    v_lshlrev_b32 v16, 16, v8
    v_and_b32 v17, 0xffff0000, v8
    v_lshlrev_b32 v32, 16, v12
    v_and_b32 v33, 0xffff0000, v12
    v_lshlrev_b32 v18, 16, v9
    v_and_b32 v19, 0xffff0000, v9
    v_lshlrev_b32 v34, 16, v13
    v_and_b32 v35, 0xffff0000, v13
    v_lshlrev_b32 v20, 16, v10
    v_and_b32 v21, 0xffff0000, v10
    v_lshlrev_b32 v36, 16, v14
    v_and_b32 v37, 0xffff0000, v14
    v_lshlrev_b32 v22, 16, v11
    v_and_b32 v23, 0xffff0000, v11
    v_lshlrev_b32 v38, 16, v15
    v_and_b32 v39, 0xffff0000, v15
    v_cndmask_b32 v16, 0, v16, vcc
    v_cndmask_b32 v32, 0, v32, vcc
    v_cndmask_b32 v17, 0, v17, vcc
    v_cndmask_b32 v33, 0, v33, vcc
    v_cndmask_b32 v18, 0, v18, vcc
    v_cndmask_b32 v34, 0, v34, vcc
    v_cndmask_b32 v19, 0, v19, vcc
    v_cndmask_b32 v35, 0, v35, vcc
    v_cndmask_b32 v20, 0, v20, vcc
    v_cndmask_b32 v36, 0, v36, vcc
    v_cndmask_b32 v21, 0, v21, vcc
    v_cndmask_b32 v37, 0, v37, vcc
    v_cndmask_b32 v22, 0, v22, vcc
    v_cndmask_b32 v38, 0, v38, vcc
    v_cndmask_b32 v23, 0, v23, vcc
    v_cndmask_b32 v39, 0, v39, vcc
    v_add_f32 v96, v16, v17
    v_add_f32 v96, v96, v18
    v_add_f32 v96, v96, v19
    v_add_f32 v96, v96, v20
    v_add_f32 v96, v96, v21
    v_add_f32 v96, v96, v22
    v_add_f32 v96, v96, v23
    v_mul_f32 v96, v96, v98
    ds_bpermute_b32 v99, v100, v96
    s_waitcnt lgkmcnt(0)
    v_add_f32 v96, v96, v99
    ds_bpermute_b32 v99, v101, v96
    s_waitcnt lgkmcnt(0)
    v_add_f32 v96, v96, v99
    ds_bpermute_b32 v99, v102, v96
    s_waitcnt lgkmcnt(0)
    v_add_f32 v96, v96, v99
    ds_bpermute_b32 v99, v103, v96
    s_waitcnt lgkmcnt(0)
    v_add_f32 v96, v96, v99
    ds_bpermute_b32 v99, v104, v96
    s_waitcnt lgkmcnt(0)
    v_add_f32 v96, v96, v99
    ds_bpermute_b32 v99, v105, v96
    s_waitcnt lgkmcnt(0)
    v_add_f32 v96, v96, v99
    v_mul_f32 v96, 0x3b124925, v96
    v_sub_f32 v24, v16, v96
    v_sub_f32 v25, v17, v96
    v_sub_f32 v26, v18, v96
    v_sub_f32 v27, v19, v96
    v_sub_f32 v28, v20, v96
    v_sub_f32 v29, v21, v96
    v_sub_f32 v30, v22, v96
    v_sub_f32 v31, v23, v96
    v_mul_f32 v97, v24, v24
    v_fma_f32 v97, v25, v25, v97
    v_fma_f32 v97, v26, v26, v97
    v_fma_f32 v97, v27, v27, v97
    v_fma_f32 v97, v28, v28, v97
    v_fma_f32 v97, v29, v29, v97
    v_fma_f32 v97, v30, v30, v97
    v_fma_f32 v97, v31, v31, v97
    v_mul_f32 v97, v97, v98
    ds_bpermute_b32 v99, v100, v97
    s_waitcnt lgkmcnt(0)
    v_add_f32 v97, v97, v99
    ds_bpermute_b32 v99, v101, v97
    s_waitcnt lgkmcnt(0)
    v_add_f32 v97, v97, v99
    ds_bpermute_b32 v99, v102, v97
    s_waitcnt lgkmcnt(0)
    v_add_f32 v97, v97, v99
    ds_bpermute_b32 v99, v103, v97
    s_waitcnt lgkmcnt(0)
    v_add_f32 v97, v97, v99
    ds_bpermute_b32 v99, v104, v97
    s_waitcnt lgkmcnt(0)
    v_add_f32 v97, v97, v99
    ds_bpermute_b32 v99, v105, v97
    s_waitcnt lgkmcnt(0)
    v_add_f32 v97, v97, v99
    v_mul_f32 v97, 0x3b124925, v97
    v_add_f32 v97, 0x3727c5ac, v97
    v_rsq_f32 v97, v97
    s_nop 1
    v_mul_f32 v24, v24, v97
    v_mul_f32 v25, v25, v97
    v_mul_f32 v26, v26, v97
    v_mul_f32 v27, v27, v97
    v_mul_f32 v28, v28, v97
    v_mul_f32 v29, v29, v97
    v_mul_f32 v30, v30, v97
    v_mul_f32 v31, v31, v97
    v_cvt_pk_bf16_f32 v24, v24, v24
    v_lshlrev_b32 v24, 16, v24
    v_mul_f32 v24, v24, v32
    v_cvt_pk_bf16_f32 v24, v24, v24
    v_lshlrev_b32 v24, 16, v24
    v_add_f32 v16, v16, v24
    v_cvt_pk_bf16_f32 v16, v16, v16
    v_lshlrev_b32 v16, 16, v16
    v_cvt_pk_bf16_f32 v25, v25, v25
    v_lshlrev_b32 v25, 16, v25
    v_mul_f32 v25, v25, v33
    v_cvt_pk_bf16_f32 v25, v25, v25
    v_lshlrev_b32 v25, 16, v25
    v_add_f32 v17, v17, v25
    v_cvt_pk_bf16_f32 v17, v17, v17
    v_lshlrev_b32 v17, 16, v17
    v_cvt_pk_bf16_f32 v26, v26, v26
    v_lshlrev_b32 v26, 16, v26
    v_mul_f32 v26, v26, v34
    v_cvt_pk_bf16_f32 v26, v26, v26
    v_lshlrev_b32 v26, 16, v26
    v_add_f32 v18, v18, v26
    v_cvt_pk_bf16_f32 v18, v18, v18
    v_lshlrev_b32 v18, 16, v18
    v_cvt_pk_bf16_f32 v27, v27, v27
    v_lshlrev_b32 v27, 16, v27
    v_mul_f32 v27, v27, v35
    v_cvt_pk_bf16_f32 v27, v27, v27
    v_lshlrev_b32 v27, 16, v27
    v_add_f32 v19, v19, v27
    v_cvt_pk_bf16_f32 v19, v19, v19
    v_lshlrev_b32 v19, 16, v19
    v_cvt_pk_bf16_f32 v28, v28, v28
    v_lshlrev_b32 v28, 16, v28
    v_mul_f32 v28, v28, v36
    v_cvt_pk_bf16_f32 v28, v28, v28
    v_lshlrev_b32 v28, 16, v28
    v_add_f32 v20, v20, v28
    v_cvt_pk_bf16_f32 v20, v20, v20
    v_lshlrev_b32 v20, 16, v20
    v_cvt_pk_bf16_f32 v29, v29, v29
    v_lshlrev_b32 v29, 16, v29
    v_mul_f32 v29, v29, v37
    v_cvt_pk_bf16_f32 v29, v29, v29
    v_lshlrev_b32 v29, 16, v29
    v_add_f32 v21, v21, v29
    v_cvt_pk_bf16_f32 v21, v21, v21
    v_lshlrev_b32 v21, 16, v21
    v_cvt_pk_bf16_f32 v30, v30, v30
    v_lshlrev_b32 v30, 16, v30
    v_mul_f32 v30, v30, v38
    v_cvt_pk_bf16_f32 v30, v30, v30
    v_lshlrev_b32 v30, 16, v30
    v_add_f32 v22, v22, v30
    v_cvt_pk_bf16_f32 v22, v22, v22
    v_lshlrev_b32 v22, 16, v22
    v_cvt_pk_bf16_f32 v31, v31, v31
    v_lshlrev_b32 v31, 16, v31
    v_mul_f32 v31, v31, v39
    v_cvt_pk_bf16_f32 v31, v31, v31
    v_lshlrev_b32 v31, 16, v31
    v_add_f32 v23, v23, v31
    v_cvt_pk_bf16_f32 v23, v23, v23
    v_lshlrev_b32 v23, 16, v23
    v_add_f32 v96, v16, v17
    v_add_f32 v96, v96, v18
    v_add_f32 v96, v96, v19
    v_add_f32 v96, v96, v20
    v_add_f32 v96, v96, v21
    v_add_f32 v96, v96, v22
    v_add_f32 v96, v96, v23
    v_mul_f32 v96, v96, v98
    ds_bpermute_b32 v99, v100, v96
    s_waitcnt lgkmcnt(0)
    v_add_f32 v96, v96, v99
    ds_bpermute_b32 v99, v101, v96
    s_waitcnt lgkmcnt(0)
    v_add_f32 v96, v96, v99
    ds_bpermute_b32 v99, v102, v96
    s_waitcnt lgkmcnt(0)
    v_add_f32 v96, v96, v99
    ds_bpermute_b32 v99, v103, v96
    s_waitcnt lgkmcnt(0)
    v_add_f32 v96, v96, v99
    ds_bpermute_b32 v99, v104, v96
    s_waitcnt lgkmcnt(0)
    v_add_f32 v96, v96, v99
    ds_bpermute_b32 v99, v105, v96
    s_waitcnt lgkmcnt(0)
    v_add_f32 v96, v96, v99
    v_mul_f32 v96, 0x3b124925, v96
    v_sub_f32 v24, v16, v96
    v_sub_f32 v25, v17, v96
    v_sub_f32 v26, v18, v96
    v_sub_f32 v27, v19, v96
    v_sub_f32 v28, v20, v96
    v_sub_f32 v29, v21, v96
    v_sub_f32 v30, v22, v96
    v_sub_f32 v31, v23, v96
    v_mul_f32 v97, v24, v24
    v_fma_f32 v97, v25, v25, v97
    v_fma_f32 v97, v26, v26, v97
    v_fma_f32 v97, v27, v27, v97
    v_fma_f32 v97, v28, v28, v97
    v_fma_f32 v97, v29, v29, v97
    v_fma_f32 v97, v30, v30, v97
    v_fma_f32 v97, v31, v31, v97
    v_mul_f32 v97, v97, v98
    ds_bpermute_b32 v99, v100, v97
    s_waitcnt lgkmcnt(0)
    v_add_f32 v97, v97, v99
    ds_bpermute_b32 v99, v101, v97
    s_waitcnt lgkmcnt(0)
    v_add_f32 v97, v97, v99
    ds_bpermute_b32 v99, v102, v97
    s_waitcnt lgkmcnt(0)
    v_add_f32 v97, v97, v99
    ds_bpermute_b32 v99, v103, v97
    s_waitcnt lgkmcnt(0)
    v_add_f32 v97, v97, v99
    ds_bpermute_b32 v99, v104, v97
    s_waitcnt lgkmcnt(0)
    v_add_f32 v97, v97, v99
    ds_bpermute_b32 v99, v105, v97
    s_waitcnt lgkmcnt(0)
    v_add_f32 v97, v97, v99
    v_mul_f32 v97, 0x3b124925, v97
    v_add_f32 v97, 0x3727c5ac, v97
    v_rsq_f32 v97, v97
    s_nop 1
    v_mul_f32 v24, v24, v97
    v_mul_f32 v25, v25, v97
    v_mul_f32 v26, v26, v97
    v_mul_f32 v27, v27, v97
    v_mul_f32 v28, v28, v97
    v_mul_f32 v29, v29, v97
    v_mul_f32 v30, v30, v97
    v_mul_f32 v31, v31, v97
    v_cvt_pk_bf16_f32 v8, v16, v17
    v_cvt_pk_bf16_f32 v12, v24, v25
    v_cvt_pk_bf16_f32 v9, v18, v19
    v_cvt_pk_bf16_f32 v13, v26, v27
    v_cvt_pk_bf16_f32 v10, v20, v21
    v_cvt_pk_bf16_f32 v14, v28, v29
    v_cvt_pk_bf16_f32 v11, v22, v23
    v_cvt_pk_bf16_f32 v15, v30, v31
    s_and_saveexec_b64 s[30:31], vcc
    buffer_store_dwordx4 v[8:11], v40, s[20:23], 0 offen
    buffer_store_dwordx4 v[12:15], v40, s[24:27], 0 offen
    v_add_u32 v40, 896, v40
    v_add_u32 v7, 912, v7
    s_add_u32 s6, s6, 1
    s_cmp_lt_u32 s6, 8
    s_cbranch_scc1 row0_loop
row0_end:
    s_endpgm
.globl gqkv_kernel
.p2align 8
.type gqkv_kernel,@function
gqkv_kernel:
    s_load_dwordx16 s[36:51], s[0:1], 0
    s_load_dwordx8 s[52:59], s[0:1], 64
    s_load_dwordx2 s[60:61], s[0:1], 104
    s_load_dwordx2 s[62:63], s[0:1], 120
    s_waitcnt lgkmcnt(0)
    s_cmp_ge_u32 s2, 3072
    s_cbranch_scc1 gqkv_end
    s_add_u32 s12, s62, 6291456
    s_addc_u32 s13, s63, 0
    s_mov_b32 s14, 1835008
    s_mov_b32 s15, 0x20000
    s_add_u32 s16, s62, 16777216
    s_addc_u32 s17, s63, 0
    s_mov_b32 s18, 11010048
    s_mov_b32 s19, 0x20000
    s_add_u32 s20, s62, 33554432
    s_addc_u32 s21, s63, 0
    s_mov_b32 s22, 50331648
    s_mov_b32 s23, 0x20000
    s_add_u32 s24, s62, 4194304
    s_addc_u32 s25, s63, 0
    s_mov_b32 s26, 1835008
    s_mov_b32 s27, 0x20000
    s_and_b32 s4, s2, 15
    s_lshr_b32 s5, s2, 4
    v_and_b32 v1, 31, v0
    v_bfe_u32 v2, v0, 5, 1
    v_bfe_u32 v3, v0, 6, 1
    v_lshrrev_b32 v4, 7, v0
    s_lshl_b32 s6, s4, 7
    v_lshl_add_u32 v5, v4, 6, v1
    v_add_u32 v5, s6, v5
    s_lshl_b32 s7, s5, 6
    v_lshl_add_u32 v6, v3, 5, v1
    v_add_u32 v6, s7, v6
    s_mov_b32 s8, 896
    v_mul_lo_u32 v7, v5, s8
    v_lshl_add_u32 v7, v2, 4, v7
    v_add_u32 v8, 28672, v7
    v_mul_lo_u32 v9, v6, s8
    v_lshl_add_u32 v9, v2, 4, v9
    v_mov_b32 v16, 0
    v_mov_b32 v17, 0
    v_mov_b32 v18, 0
    v_mov_b32 v19, 0
    v_mov_b32 v20, 0
    v_mov_b32 v21, 0
    v_mov_b32 v22, 0
    v_mov_b32 v23, 0
    v_mov_b32 v24, 0
    v_mov_b32 v25, 0
    v_mov_b32 v26, 0
    v_mov_b32 v27, 0
    v_mov_b32 v28, 0
    v_mov_b32 v29, 0
    v_mov_b32 v30, 0
    v_mov_b32 v31, 0
    v_mov_b32 v32, 0
    v_mov_b32 v33, 0
    v_mov_b32 v34, 0
    v_mov_b32 v35, 0
    v_mov_b32 v36, 0
    v_mov_b32 v37, 0
    v_mov_b32 v38, 0
    v_mov_b32 v39, 0
    v_mov_b32 v40, 0
    v_mov_b32 v41, 0
    v_mov_b32 v42, 0
    v_mov_b32 v43, 0
    v_mov_b32 v44, 0
    v_mov_b32 v45, 0
    v_mov_b32 v46, 0
    v_mov_b32 v47, 0
    s_mov_b32 s9, 0
gqkv_loop:
    buffer_load_dwordx4 v[48:51], v9, s[16:19], s9 offen offset:0
    buffer_load_dwordx4 v[52:55], v7, s[12:15], s9 offen offset:0
    buffer_load_dwordx4 v[56:59], v8, s[12:15], s9 offen offset:0
    buffer_load_dwordx4 v[60:63], v9, s[16:19], s9 offen offset:32
    buffer_load_dwordx4 v[64:67], v7, s[12:15], s9 offen offset:32
    buffer_load_dwordx4 v[68:71], v8, s[12:15], s9 offen offset:32
    buffer_load_dwordx4 v[72:75], v9, s[16:19], s9 offen offset:64
    buffer_load_dwordx4 v[76:79], v7, s[12:15], s9 offen offset:64
    buffer_load_dwordx4 v[80:83], v8, s[12:15], s9 offen offset:64
    buffer_load_dwordx4 v[84:87], v9, s[16:19], s9 offen offset:96
    buffer_load_dwordx4 v[88:91], v7, s[12:15], s9 offen offset:96
    buffer_load_dwordx4 v[92:95], v8, s[12:15], s9 offen offset:96
    s_waitcnt vmcnt(9)
    v_mfma_f32_32x32x16_bf16 v[16:31], v[48:51], v[52:55], v[16:31]
    v_mfma_f32_32x32x16_bf16 v[32:47], v[48:51], v[56:59], v[32:47]
    s_waitcnt vmcnt(6)
    v_mfma_f32_32x32x16_bf16 v[16:31], v[60:63], v[64:67], v[16:31]
    v_mfma_f32_32x32x16_bf16 v[32:47], v[60:63], v[68:71], v[32:47]
    s_waitcnt vmcnt(3)
    v_mfma_f32_32x32x16_bf16 v[16:31], v[72:75], v[76:79], v[16:31]
    v_mfma_f32_32x32x16_bf16 v[32:47], v[72:75], v[80:83], v[32:47]
    s_waitcnt vmcnt(0)
    v_mfma_f32_32x32x16_bf16 v[16:31], v[84:87], v[88:91], v[16:31]
    v_mfma_f32_32x32x16_bf16 v[32:47], v[84:87], v[92:95], v[32:47]
    s_add_u32 s9, s9, 128
    s_cmp_lt_u32 s9, 896
    s_cbranch_scc1 gqkv_loop
    s_nop 15
    s_mov_b32 s8, 24576
    v_mul_lo_u32 v7, v5, s8
    v_lshl_add_u32 v10, v3, 5, 0
    v_add_u32 v10, s7, v10
    v_lshl_add_u32 v10, v2, 2, v10
    v_lshl_add_u32 v7, v10, 1, v7
    v_add_u32 v8, 0, v7
    v_cvt_pk_bf16_f32 v10, v16, v17
    v_cvt_pk_bf16_f32 v11, v18, v19
    buffer_store_dwordx2 v[10:11], v8, s[20:23], 0 offen
    s_nop 1
    v_add_u32 v8, 16, v7
    v_cvt_pk_bf16_f32 v10, v20, v21
    v_cvt_pk_bf16_f32 v11, v22, v23
    buffer_store_dwordx2 v[10:11], v8, s[20:23], 0 offen
    s_nop 1
    v_add_u32 v8, 32, v7
    v_cvt_pk_bf16_f32 v10, v24, v25
    v_cvt_pk_bf16_f32 v11, v26, v27
    buffer_store_dwordx2 v[10:11], v8, s[20:23], 0 offen
    s_nop 1
    v_add_u32 v8, 48, v7
    v_cvt_pk_bf16_f32 v10, v28, v29
    v_cvt_pk_bf16_f32 v11, v30, v31
    buffer_store_dwordx2 v[10:11], v8, s[20:23], 0 offen
    s_nop 1
    v_add_u32 v8, 786432, v7
    v_cvt_pk_bf16_f32 v10, v32, v33
    v_cvt_pk_bf16_f32 v11, v34, v35
    buffer_store_dwordx2 v[10:11], v8, s[20:23], 0 offen
    s_nop 1
    v_add_u32 v8, 786448, v7
    v_cvt_pk_bf16_f32 v10, v36, v37
    v_cvt_pk_bf16_f32 v11, v38, v39
    buffer_store_dwordx2 v[10:11], v8, s[20:23], 0 offen
    s_nop 1
    v_add_u32 v8, 786464, v7
    v_cvt_pk_bf16_f32 v10, v40, v41
    v_cvt_pk_bf16_f32 v11, v42, v43
    buffer_store_dwordx2 v[10:11], v8, s[20:23], 0 offen
    s_nop 1
    v_add_u32 v8, 786480, v7
    v_cvt_pk_bf16_f32 v10, v44, v45
    v_cvt_pk_bf16_f32 v11, v46, v47
    buffer_store_dwordx2 v[10:11], v8, s[20:23], 0 offen
    s_nop 1
gqkv_end:
    s_endpgm
.globl chain0_kernel
.p2align 8
.type chain0_kernel,@function
chain0_kernel:
    s_load_dwordx16 s[36:51], s[0:1], 0
    s_load_dwordx8 s[52:59], s[0:1], 64
    s_load_dwordx2 s[60:61], s[0:1], 104
    s_load_dwordx2 s[62:63], s[0:1], 120
    s_waitcnt lgkmcnt(0)
    s_cmp_ge_u32 s2, 64
    s_cbranch_scc1 c0_end
    s_add_u32 s4, s62, 16777216
    s_addc_u32 s5, s63, 0
    s_mov_b32 s6, 11010048
    s_mov_b32 s7, 0x20000
    s_add_u32 s8, s62, 29360128
    s_addc_u32 s9, s63, 0
    s_mov_b32 s10, 3670016
    s_mov_b32 s11, 0x20000
    s_add_u32 s12, s62, 33554432
    s_addc_u32 s13, s63, 0
    s_mov_b32 s14, 50331648
    s_mov_b32 s15, 0x20000
    s_add_u32 s16, s62, 119537664
    s_addc_u32 s17, s63, 0
    s_mov_b32 s18, 8388608
    s_mov_b32 s19, 0x20000
    s_add_u32 s20, s62, 134217728
    s_addc_u32 s21, s63, 0
    s_mov_b32 s22, 1048576
    s_mov_b32 s23, 0x20000
    s_add_u32 s24, s62, 135266304
    s_addc_u32 s25, s63, 0
    s_mov_b32 s26, 5242880
    s_mov_b32 s27, 0x20000
    s_add_u32 s28, s62, 140509184
    s_addc_u32 s29, s63, 0
    s_mov_b32 s30, 65536
    s_mov_b32 s31, 0x20000
    s_mov_b32 s64, s50
    s_mov_b32 s65, s51
    s_mov_b32 s66, 7168
    s_mov_b32 s67, 0x20000
    v_and_b32 v1, 15, v0
    v_bfe_u32 v2, v0, 4, 2
    v_lshrrev_b32 v3, 6, v0
    s_nop 1
    v_readfirstlane_b32 s68, v3
    s_lshl_b32 s69, s2, 6
    v_lshl_add_u32 v4, v3, 4, v1
    v_add_u32 v4, s69, v4
    v_mul_u32_u24 v4, 896, v4
    v_lshl_add_u32 v4, v2, 4, v4
    buffer_load_dwordx4 a[0:3], v4, s[4:7], 0 offen offset:0
    buffer_load_dwordx4 a[4:7], v4, s[4:7], 0 offen offset:64
    buffer_load_dwordx4 a[8:11], v4, s[4:7], 0 offen offset:128
    buffer_load_dwordx4 a[12:15], v4, s[4:7], 0 offen offset:192
    buffer_load_dwordx4 a[16:19], v4, s[4:7], 0 offen offset:256
    buffer_load_dwordx4 a[20:23], v4, s[4:7], 0 offen offset:320
    buffer_load_dwordx4 a[24:27], v4, s[4:7], 0 offen offset:384
    buffer_load_dwordx4 a[28:31], v4, s[4:7], 0 offen offset:448
    buffer_load_dwordx4 a[32:35], v4, s[4:7], 0 offen offset:512
    buffer_load_dwordx4 a[36:39], v4, s[4:7], 0 offen offset:576
    buffer_load_dwordx4 a[40:43], v4, s[4:7], 0 offen offset:640
    buffer_load_dwordx4 a[44:47], v4, s[4:7], 0 offen offset:704
    buffer_load_dwordx4 a[48:51], v4, s[4:7], 0 offen offset:768
    buffer_load_dwordx4 a[52:55], v4, s[4:7], 0 offen offset:832
    v_add_u32 v4, 0x380000, v4
    buffer_load_dwordx4 a[56:59], v4, s[4:7], 0 offen offset:0
    buffer_load_dwordx4 a[60:63], v4, s[4:7], 0 offen offset:64
    buffer_load_dwordx4 a[64:67], v4, s[4:7], 0 offen offset:128
    buffer_load_dwordx4 a[68:71], v4, s[4:7], 0 offen offset:192
    buffer_load_dwordx4 a[72:75], v4, s[4:7], 0 offen offset:256
    buffer_load_dwordx4 a[76:79], v4, s[4:7], 0 offen offset:320
    buffer_load_dwordx4 a[80:83], v4, s[4:7], 0 offen offset:384
    buffer_load_dwordx4 a[84:87], v4, s[4:7], 0 offen offset:448
    buffer_load_dwordx4 a[88:91], v4, s[4:7], 0 offen offset:512
    buffer_load_dwordx4 a[92:95], v4, s[4:7], 0 offen offset:576
    buffer_load_dwordx4 a[96:99], v4, s[4:7], 0 offen offset:640
    buffer_load_dwordx4 a[100:103], v4, s[4:7], 0 offen offset:704
    buffer_load_dwordx4 a[104:107], v4, s[4:7], 0 offen offset:768
    buffer_load_dwordx4 a[108:111], v4, s[4:7], 0 offen offset:832
    v_add_u32 v4, 0x380000, v4
    buffer_load_dwordx4 a[112:115], v4, s[4:7], 0 offen offset:0
    buffer_load_dwordx4 a[116:119], v4, s[4:7], 0 offen offset:64
    buffer_load_dwordx4 a[120:123], v4, s[4:7], 0 offen offset:128
    buffer_load_dwordx4 a[124:127], v4, s[4:7], 0 offen offset:192
    buffer_load_dwordx4 a[128:131], v4, s[4:7], 0 offen offset:256
    buffer_load_dwordx4 a[132:135], v4, s[4:7], 0 offen offset:320
    buffer_load_dwordx4 a[136:139], v4, s[4:7], 0 offen offset:384
    buffer_load_dwordx4 a[140:143], v4, s[4:7], 0 offen offset:448
    buffer_load_dwordx4 a[144:147], v4, s[4:7], 0 offen offset:512
    buffer_load_dwordx4 a[148:151], v4, s[4:7], 0 offen offset:576
    buffer_load_dwordx4 a[152:155], v4, s[4:7], 0 offen offset:640
    buffer_load_dwordx4 a[156:159], v4, s[4:7], 0 offen offset:704
    buffer_load_dwordx4 a[160:163], v4, s[4:7], 0 offen offset:768
    buffer_load_dwordx4 a[164:167], v4, s[4:7], 0 offen offset:832
    v_add_u32 v4, 0x380000, v4
    v_mul_u32_u24 v4, 112, v3
    v_add_u32 v4, v4, v1
    v_lshlrev_b32 v4, 13, v4
    v_lshl_add_u32 v4, v2, 4, v4
    s_lshl_b32 s70, s69, 1
    v_add_u32 v4, s70, v4
    buffer_load_dwordx4 a[168:171], v4, s[8:11], 0 offen offset:0
    buffer_load_dwordx4 a[172:175], v4, s[8:11], 0 offen offset:64
    v_add_u32 v4, 0x20000, v4
    buffer_load_dwordx4 a[176:179], v4, s[8:11], 0 offen offset:0
    buffer_load_dwordx4 a[180:183], v4, s[8:11], 0 offen offset:64
    v_add_u32 v4, 0x20000, v4
    buffer_load_dwordx4 a[184:187], v4, s[8:11], 0 offen offset:0
    buffer_load_dwordx4 a[188:191], v4, s[8:11], 0 offen offset:64
    v_add_u32 v4, 0x20000, v4
    buffer_load_dwordx4 a[192:195], v4, s[8:11], 0 offen offset:0
    buffer_load_dwordx4 a[196:199], v4, s[8:11], 0 offen offset:64
    v_add_u32 v4, 0x20000, v4
    buffer_load_dwordx4 a[200:203], v4, s[8:11], 0 offen offset:0
    buffer_load_dwordx4 a[204:207], v4, s[8:11], 0 offen offset:64
    v_add_u32 v4, 0x20000, v4
    buffer_load_dwordx4 a[208:211], v4, s[8:11], 0 offen offset:0
    buffer_load_dwordx4 a[212:215], v4, s[8:11], 0 offen offset:64
    v_add_u32 v4, 0x20000, v4
    buffer_load_dwordx4 a[216:219], v4, s[8:11], 0 offen offset:0
    buffer_load_dwordx4 a[220:223], v4, s[8:11], 0 offen offset:64
    v_add_u32 v4, 0x20000, v4
    v_mov_b32 v240, 0
    v_mov_b32 v241, 0
    v_mov_b32 v242, 0
    v_mov_b32 v243, 0
    v_lshlrev_b32 v5, 4, v0
    ds_write_b128 v5, v[240:243] offset:0
    ds_write_b128 v5, v[240:243] offset:4096
    ds_write_b128 v5, v[240:243] offset:8192
    ds_write_b128 v5, v[240:243] offset:12288
    v_and_b32 v6, 7, v0
    v_mul_u32_u24 v7, 896, v6
    v_lshl_add_u32 v7, v2, 4, v7
    buffer_load_dwordx4 v[176:179], v7, s[64:67], 0 offen offset:0
    buffer_load_dwordx4 v[180:183], v7, s[64:67], 0 offen offset:64
    buffer_load_dwordx4 v[184:187], v7, s[64:67], 0 offen offset:128
    buffer_load_dwordx4 v[188:191], v7, s[64:67], 0 offen offset:192
    buffer_load_dwordx4 v[192:195], v7, s[64:67], 0 offen offset:256
    buffer_load_dwordx4 v[196:199], v7, s[64:67], 0 offen offset:320
    buffer_load_dwordx4 v[200:203], v7, s[64:67], 0 offen offset:384
    buffer_load_dwordx4 v[204:207], v7, s[64:67], 0 offen offset:448
    buffer_load_dwordx4 v[208:211], v7, s[64:67], 0 offen offset:512
    buffer_load_dwordx4 v[212:215], v7, s[64:67], 0 offen offset:576
    buffer_load_dwordx4 v[216:219], v7, s[64:67], 0 offen offset:640
    buffer_load_dwordx4 v[220:223], v7, s[64:67], 0 offen offset:704
    buffer_load_dwordx4 v[224:227], v7, s[64:67], 0 offen offset:768
    buffer_load_dwordx4 v[228:231], v7, s[64:67], 0 offen offset:832
    s_waitcnt vmcnt(0) lgkmcnt(0)
    s_barrier
    s_mov_b32 s71, 0
c0_loop:
    s_add_u32 s72, s71, 1
    s_and_b32 s73, s71, 1
    v_mov_b32 v232, 0
    v_mov_b32 v233, 0
    v_mov_b32 v234, 0
    v_mov_b32 v235, 0
    v_mov_b32 v236, 0
    v_mov_b32 v237, 0
    v_mov_b32 v238, 0
    v_mov_b32 v239, 0
    v_mov_b32 v240, 0
    v_mov_b32 v241, 0
    v_mov_b32 v242, 0
    v_mov_b32 v243, 0
    s_nop 1
    s_mul_i32 s74, s71, 786432
    s_add_u32 s74, s74, s70
    v_lshrrev_b32 v244, 3, v0
    v_mul_u32_u24 v245, 24576, v244
    v_and_b32 v246, 7, v0
    v_lshl_add_u32 v245, v246, 4, v245
    buffer_load_dwordx4 v[120:123], v245, s[12:15], s74 offen offset:0
    v_mfma_f32_16x16x32_bf16 v[232:235], a[0:3], v[176:179], v[232:235]
    v_mfma_f32_16x16x32_bf16 v[236:239], a[56:59], v[176:179], v[236:239]
    v_mfma_f32_16x16x32_bf16 v[240:243], a[112:115], v[176:179], v[240:243]
    v_mfma_f32_16x16x32_bf16 v[232:235], a[4:7], v[180:183], v[232:235]
    v_mfma_f32_16x16x32_bf16 v[236:239], a[60:63], v[180:183], v[236:239]
    v_mfma_f32_16x16x32_bf16 v[240:243], a[116:119], v[180:183], v[240:243]
    v_mfma_f32_16x16x32_bf16 v[232:235], a[8:11], v[184:187], v[232:235]
    v_mfma_f32_16x16x32_bf16 v[236:239], a[64:67], v[184:187], v[236:239]
    v_mfma_f32_16x16x32_bf16 v[240:243], a[120:123], v[184:187], v[240:243]
    v_mfma_f32_16x16x32_bf16 v[232:235], a[12:15], v[188:191], v[232:235]
    v_mfma_f32_16x16x32_bf16 v[236:239], a[68:71], v[188:191], v[236:239]
    v_mfma_f32_16x16x32_bf16 v[240:243], a[124:127], v[188:191], v[240:243]
    v_mfma_f32_16x16x32_bf16 v[232:235], a[16:19], v[192:195], v[232:235]
    v_mfma_f32_16x16x32_bf16 v[236:239], a[72:75], v[192:195], v[236:239]
    v_mfma_f32_16x16x32_bf16 v[240:243], a[128:131], v[192:195], v[240:243]
    v_mfma_f32_16x16x32_bf16 v[232:235], a[20:23], v[196:199], v[232:235]
    v_mfma_f32_16x16x32_bf16 v[236:239], a[76:79], v[196:199], v[236:239]
    v_mfma_f32_16x16x32_bf16 v[240:243], a[132:135], v[196:199], v[240:243]
    v_mfma_f32_16x16x32_bf16 v[232:235], a[24:27], v[200:203], v[232:235]
    v_mfma_f32_16x16x32_bf16 v[236:239], a[80:83], v[200:203], v[236:239]
    v_mfma_f32_16x16x32_bf16 v[240:243], a[136:139], v[200:203], v[240:243]
    v_mfma_f32_16x16x32_bf16 v[232:235], a[28:31], v[204:207], v[232:235]
    v_mfma_f32_16x16x32_bf16 v[236:239], a[84:87], v[204:207], v[236:239]
    v_mfma_f32_16x16x32_bf16 v[240:243], a[140:143], v[204:207], v[240:243]
    v_mfma_f32_16x16x32_bf16 v[232:235], a[32:35], v[208:211], v[232:235]
    v_mfma_f32_16x16x32_bf16 v[236:239], a[88:91], v[208:211], v[236:239]
    v_mfma_f32_16x16x32_bf16 v[240:243], a[144:147], v[208:211], v[240:243]
    v_mfma_f32_16x16x32_bf16 v[232:235], a[36:39], v[212:215], v[232:235]
    v_mfma_f32_16x16x32_bf16 v[236:239], a[92:95], v[212:215], v[236:239]
    v_mfma_f32_16x16x32_bf16 v[240:243], a[148:151], v[212:215], v[240:243]
    v_mfma_f32_16x16x32_bf16 v[232:235], a[40:43], v[216:219], v[232:235]
    v_mfma_f32_16x16x32_bf16 v[236:239], a[96:99], v[216:219], v[236:239]
    v_mfma_f32_16x16x32_bf16 v[240:243], a[152:155], v[216:219], v[240:243]
    v_mfma_f32_16x16x32_bf16 v[232:235], a[44:47], v[220:223], v[232:235]
    v_mfma_f32_16x16x32_bf16 v[236:239], a[100:103], v[220:223], v[236:239]
    v_mfma_f32_16x16x32_bf16 v[240:243], a[156:159], v[220:223], v[240:243]
    v_mfma_f32_16x16x32_bf16 v[232:235], a[48:51], v[224:227], v[232:235]
    v_mfma_f32_16x16x32_bf16 v[236:239], a[104:107], v[224:227], v[236:239]
    v_mfma_f32_16x16x32_bf16 v[240:243], a[160:163], v[224:227], v[240:243]
    v_mfma_f32_16x16x32_bf16 v[232:235], a[52:55], v[228:231], v[232:235]
    v_mfma_f32_16x16x32_bf16 v[236:239], a[108:111], v[228:231], v[236:239]
    v_mfma_f32_16x16x32_bf16 v[240:243], a[164:167], v[228:231], v[240:243]
    s_nop 7
    v_cmp_gt_u32 vcc, 8, v1
    s_nop 1
    s_and_saveexec_b64 s[76:77], vcc
    v_cvt_pk_bf16_f32 v124, v232, v233
    v_cvt_pk_bf16_f32 v125, v234, v235
    v_cvt_pk_bf16_f32 v126, v236, v237
    v_cvt_pk_bf16_f32 v127, v238, v239
    v_cvt_pk_bf16_f32 v128, v240, v241
    v_cvt_pk_bf16_f32 v129, v242, v243
    v_lshlrev_b32 v247, 7, v1
    v_lshl_add_u32 v247, v3, 5, v247
    v_lshl_add_u32 v247, v2, 3, v247
    ds_write_b64 v247, v[124:125]
    ds_write_b64 v247, v[126:127] offset:1024
    v_lshlrev_b32 v248, 14, v1
    v_lshl_add_u32 v248, v3, 5, v248
    v_lshl_add_u32 v248, v2, 3, v248
    s_lshl_b32 s75, s71, 17
    s_add_u32 s75, s75, s70
    buffer_store_dwordx2 v[126:127], v248, s[16:19], s75 offen
    v_add_u32 v249, 8192, v248
    buffer_store_dwordx2 v[128:129], v249, s[16:19], s75 offen
    v_lshlrev_b32 v247, 2, v2
    v_lshl_add_u32 v247, v3, 4, v247
    v_mul_u32_u24 v247, 144, v247
    v_lshl_add_u32 v247, v1, 1, v247
    ds_write_b16 v247, v128 offset:2048
    ds_write_b16_d16_hi v247, v128 offset:2192
    ds_write_b16 v247, v129 offset:2336
    ds_write_b16_d16_hi v247, v129 offset:2480
    s_or_b64 exec, exec, s[76:77]
    v_add_u32 v245, 16384, v245
    buffer_load_dwordx4 v[120:123], v245, s[12:15], s74 offen
    s_waitcnt vmcnt(0)
    v_mul_u32_u24 v247, 1152, v246
    v_lshl_add_u32 v247, v244, 1, v247
    ds_write_b16 v247, v120 offset:2064
    ds_write_b16_d16_hi v247, v120 offset:2208
    ds_write_b16 v247, v121 offset:2352
    ds_write_b16_d16_hi v247, v121 offset:2496
    ds_write_b16 v247, v122 offset:2640
    ds_write_b16_d16_hi v247, v122 offset:2784
    ds_write_b16 v247, v123 offset:2928
    ds_write_b16_d16_hi v247, v123 offset:3072
    s_waitcnt lgkmcnt(0)
    s_barrier
    s_cmp_lg_u32 s68, 0
    s_cbranch_scc1 c0_skipS
    v_and_b32 v6, 7, v1
    v_lshlrev_b32 v247, 7, v6
    v_lshl_add_u32 v247, v2, 4, v247
    ds_read_b128 v[120:123], v247 offset:0
    ds_read_b128 v[128:131], v247 offset:1024
    ds_read_b128 v[124:127], v247 offset:64
    ds_read_b128 v[132:135], v247 offset:1088
    v_mul_u32_u24 v248, 24576, v1
    v_lshl_add_u32 v248, v2, 4, v248
    v_add_u32 v248, 8192, v248
    buffer_load_dwordx4 v[136:139], v248, s[12:15], s74 offen offset:0
    buffer_load_dwordx4 v[140:143], v248, s[12:15], s74 offen offset:64
    v_add_u32 v248, 393216, v248
    buffer_load_dwordx4 v[144:147], v248, s[12:15], s74 offen offset:0
    buffer_load_dwordx4 v[148:151], v248, s[12:15], s74 offen offset:64
    v_add_u32 v248, 393216, v248
    v_mov_b32 v232, 0
    v_mov_b32 v233, 0
    v_mov_b32 v234, 0
    v_mov_b32 v235, 0
    v_mov_b32 v236, 0
    v_mov_b32 v237, 0
    v_mov_b32 v238, 0
    v_mov_b32 v239, 0
    v_mov_b32 v240, 0
    v_mov_b32 v241, 0
    v_mov_b32 v242, 0
    v_mov_b32 v243, 0
    s_waitcnt vmcnt(0) lgkmcnt(0)
    v_mfma_f32_16x16x32_bf16 v[232:235], v[128:131], v[120:123], v[232:235]
    v_mfma_f32_16x16x32_bf16 v[232:235], v[132:135], v[124:127], v[232:235]
    v_mfma_f32_16x16x32_bf16 v[236:239], v[136:139], v[120:123], v[236:239]
    v_mfma_f32_16x16x32_bf16 v[236:239], v[140:143], v[124:127], v[236:239]
    v_mfma_f32_16x16x32_bf16 v[240:243], v[144:147], v[120:123], v[240:243]
    v_mfma_f32_16x16x32_bf16 v[240:243], v[148:151], v[124:127], v[240:243]
    s_nop 7
    s_lshl_b32 s78, s73, 6
    s_and_b32 s79, s2, 60
    s_add_u32 s79, s79, s78
    s_add_u32 s78, s78, s2
    s_mul_i32 s78, s78, 6144
    s_mul_i32 s79, s79, 6144
    v_and_b32 v247, 63, v0
    v_lshlrev_b32 v247, 5, v247
    v_mov_b32 v120, v232
    v_mov_b32 v121, s72
    v_mov_b32 v122, v233
    v_mov_b32 v123, s72
    buffer_store_dwordx4 v[120:123], v247, s[20:23], s78 offen offset:0 sc1
    s_nop 2
    v_mov_b32 v120, v234
    v_mov_b32 v121, s72
    v_mov_b32 v122, v235
    v_mov_b32 v123, s72
    buffer_store_dwordx4 v[120:123], v247, s[20:23], s78 offen offset:16 sc1
    s_nop 2
    v_mov_b32 v120, v236
    v_mov_b32 v121, s72
    v_mov_b32 v122, v237
    v_mov_b32 v123, s72
    buffer_store_dwordx4 v[120:123], v247, s[20:23], s78 offen offset:2048 sc1
    s_nop 2
    v_mov_b32 v120, v238
    v_mov_b32 v121, s72
    v_mov_b32 v122, v239
    v_mov_b32 v123, s72
    buffer_store_dwordx4 v[120:123], v247, s[20:23], s78 offen offset:2064 sc1
    s_nop 2
    v_mov_b32 v120, v240
    v_mov_b32 v121, s72
    v_mov_b32 v122, v241
    v_mov_b32 v123, s72
    buffer_store_dwordx4 v[120:123], v247, s[20:23], s78 offen offset:4096 sc1
    s_nop 2
    v_mov_b32 v120, v242
    v_mov_b32 v121, s72
    v_mov_b32 v122, v243
    v_mov_b32 v123, s72
    buffer_store_dwordx4 v[120:123], v247, s[20:23], s78 offen offset:4112 sc1
    s_nop 2
    s_mov_b32 s33, 0
p1890:
    buffer_load_dwordx4 v[8:11], v247, s[20:23], s79 offen offset:0 sc1
    buffer_load_dwordx4 v[12:15], v247, s[20:23], s79 offen offset:16 sc1
    buffer_load_dwordx4 v[16:19], v247, s[20:23], s79 offen offset:2048 sc1
    buffer_load_dwordx4 v[20:23], v247, s[20:23], s79 offen offset:2064 sc1
    buffer_load_dwordx4 v[24:27], v247, s[20:23], s79 offen offset:4096 sc1
    buffer_load_dwordx4 v[28:31], v247, s[20:23], s79 offen offset:4112 sc1
    s_add_u32 s79, s79, 6144
    buffer_load_dwordx4 v[32:35], v247, s[20:23], s79 offen offset:0 sc1
    buffer_load_dwordx4 v[36:39], v247, s[20:23], s79 offen offset:16 sc1
    buffer_load_dwordx4 v[40:43], v247, s[20:23], s79 offen offset:2048 sc1
    buffer_load_dwordx4 v[44:47], v247, s[20:23], s79 offen offset:2064 sc1
    buffer_load_dwordx4 v[48:51], v247, s[20:23], s79 offen offset:4096 sc1
    buffer_load_dwordx4 v[52:55], v247, s[20:23], s79 offen offset:4112 sc1
    s_add_u32 s79, s79, 6144
    buffer_load_dwordx4 v[56:59], v247, s[20:23], s79 offen offset:0 sc1
    buffer_load_dwordx4 v[60:63], v247, s[20:23], s79 offen offset:16 sc1
    buffer_load_dwordx4 v[64:67], v247, s[20:23], s79 offen offset:2048 sc1
    buffer_load_dwordx4 v[68:71], v247, s[20:23], s79 offen offset:2064 sc1
    buffer_load_dwordx4 v[72:75], v247, s[20:23], s79 offen offset:4096 sc1
    buffer_load_dwordx4 v[76:79], v247, s[20:23], s79 offen offset:4112 sc1
    s_add_u32 s79, s79, 6144
    buffer_load_dwordx4 v[80:83], v247, s[20:23], s79 offen offset:0 sc1
    buffer_load_dwordx4 v[84:87], v247, s[20:23], s79 offen offset:16 sc1
    buffer_load_dwordx4 v[88:91], v247, s[20:23], s79 offen offset:2048 sc1
    buffer_load_dwordx4 v[92:95], v247, s[20:23], s79 offen offset:2064 sc1
    buffer_load_dwordx4 v[96:99], v247, s[20:23], s79 offen offset:4096 sc1
    buffer_load_dwordx4 v[100:103], v247, s[20:23], s79 offen offset:4112 sc1
    s_add_u32 s79, s79, 6144
    s_sub_u32 s79, s79, 24576
    s_waitcnt vmcnt(0)
    v_xor_b32 v250, s72, v9
    v_xor_b32 v251, s72, v11
    v_or_b32 v250, v250, v251
    v_xor_b32 v251, s72, v13
    v_or_b32 v250, v250, v251
    v_xor_b32 v251, s72, v15
    v_or_b32 v250, v250, v251
    v_xor_b32 v251, s72, v17
    v_or_b32 v250, v250, v251
    v_xor_b32 v251, s72, v19
    v_or_b32 v250, v250, v251
    v_xor_b32 v251, s72, v21
    v_or_b32 v250, v250, v251
    v_xor_b32 v251, s72, v23
    v_or_b32 v250, v250, v251
    v_xor_b32 v251, s72, v25
    v_or_b32 v250, v250, v251
    v_xor_b32 v251, s72, v27
    v_or_b32 v250, v250, v251
    v_xor_b32 v251, s72, v29
    v_or_b32 v250, v250, v251
    v_xor_b32 v251, s72, v31
    v_or_b32 v250, v250, v251
    v_xor_b32 v251, s72, v33
    v_or_b32 v250, v250, v251
    v_xor_b32 v251, s72, v35
    v_or_b32 v250, v250, v251
    v_xor_b32 v251, s72, v37
    v_or_b32 v250, v250, v251
    v_xor_b32 v251, s72, v39
    v_or_b32 v250, v250, v251
    v_xor_b32 v251, s72, v41
    v_or_b32 v250, v250, v251
    v_xor_b32 v251, s72, v43
    v_or_b32 v250, v250, v251
    v_xor_b32 v251, s72, v45
    v_or_b32 v250, v250, v251
    v_xor_b32 v251, s72, v47
    v_or_b32 v250, v250, v251
    v_xor_b32 v251, s72, v49
    v_or_b32 v250, v250, v251
    v_xor_b32 v251, s72, v51
    v_or_b32 v250, v250, v251
    v_xor_b32 v251, s72, v53
    v_or_b32 v250, v250, v251
    v_xor_b32 v251, s72, v55
    v_or_b32 v250, v250, v251
    v_xor_b32 v251, s72, v57
    v_or_b32 v250, v250, v251
    v_xor_b32 v251, s72, v59
    v_or_b32 v250, v250, v251
    v_xor_b32 v251, s72, v61
    v_or_b32 v250, v250, v251
    v_xor_b32 v251, s72, v63
    v_or_b32 v250, v250, v251
    v_xor_b32 v251, s72, v65
    v_or_b32 v250, v250, v251
    v_xor_b32 v251, s72, v67
    v_or_b32 v250, v250, v251
    v_xor_b32 v251, s72, v69
    v_or_b32 v250, v250, v251
    v_xor_b32 v251, s72, v71
    v_or_b32 v250, v250, v251
    v_xor_b32 v251, s72, v73
    v_or_b32 v250, v250, v251
    v_xor_b32 v251, s72, v75
    v_or_b32 v250, v250, v251
    v_xor_b32 v251, s72, v77
    v_or_b32 v250, v250, v251
    v_xor_b32 v251, s72, v79
    v_or_b32 v250, v250, v251
    v_xor_b32 v251, s72, v81
    v_or_b32 v250, v250, v251
    v_xor_b32 v251, s72, v83
    v_or_b32 v250, v250, v251
    v_xor_b32 v251, s72, v85
    v_or_b32 v250, v250, v251
    v_xor_b32 v251, s72, v87
    v_or_b32 v250, v250, v251
    v_xor_b32 v251, s72, v89
    v_or_b32 v250, v250, v251
    v_xor_b32 v251, s72, v91
    v_or_b32 v250, v250, v251
    v_xor_b32 v251, s72, v93
    v_or_b32 v250, v250, v251
    v_xor_b32 v251, s72, v95
    v_or_b32 v250, v250, v251
    v_xor_b32 v251, s72, v97
    v_or_b32 v250, v250, v251
    v_xor_b32 v251, s72, v99
    v_or_b32 v250, v250, v251
    v_xor_b32 v251, s72, v101
    v_or_b32 v250, v250, v251
    v_xor_b32 v251, s72, v103
    v_or_b32 v250, v250, v251
    v_cmp_ne_u32 vcc, 0, v250
    s_add_u32 s33, s33, 1
    s_cmp_gt_u32 s33, 400000
    s_cbranch_scc1 p1890x
    s_nop 3
    s_cbranch_vccnz p1890
p1890x:
    v_add_f32 v232, v8, v32
    v_add_f32 v232, v232, v56
    v_add_f32 v232, v232, v80
    v_cvt_pk_bf16_f32 v232, v232, v232
    v_lshlrev_b32 v232, 16, v232
    v_mul_f32 v232, 0x3d800000, v232
    v_add_f32 v233, v10, v34
    v_add_f32 v233, v233, v58
    v_add_f32 v233, v233, v82
    v_cvt_pk_bf16_f32 v233, v233, v233
    v_lshlrev_b32 v233, 16, v233
    v_mul_f32 v233, 0x3d800000, v233
    v_add_f32 v234, v12, v36
    v_add_f32 v234, v234, v60
    v_add_f32 v234, v234, v84
    v_cvt_pk_bf16_f32 v234, v234, v234
    v_lshlrev_b32 v234, 16, v234
    v_mul_f32 v234, 0x3d800000, v234
    v_add_f32 v235, v14, v38
    v_add_f32 v235, v235, v62
    v_add_f32 v235, v235, v86
    v_cvt_pk_bf16_f32 v235, v235, v235
    v_lshlrev_b32 v235, 16, v235
    v_mul_f32 v235, 0x3d800000, v235
    v_add_f32 v236, v16, v40
    v_add_f32 v236, v236, v64
    v_add_f32 v236, v236, v88
    v_cvt_pk_bf16_f32 v236, v236, v236
    v_lshlrev_b32 v236, 16, v236
    v_mul_f32 v236, 0x3d800000, v236
    v_add_f32 v237, v18, v42
    v_add_f32 v237, v237, v66
    v_add_f32 v237, v237, v90
    v_cvt_pk_bf16_f32 v237, v237, v237
    v_lshlrev_b32 v237, 16, v237
    v_mul_f32 v237, 0x3d800000, v237
    v_add_f32 v238, v20, v44
    v_add_f32 v238, v238, v68
    v_add_f32 v238, v238, v92
    v_cvt_pk_bf16_f32 v238, v238, v238
    v_lshlrev_b32 v238, 16, v238
    v_mul_f32 v238, 0x3d800000, v238
    v_add_f32 v239, v22, v46
    v_add_f32 v239, v239, v70
    v_add_f32 v239, v239, v94
    v_cvt_pk_bf16_f32 v239, v239, v239
    v_lshlrev_b32 v239, 16, v239
    v_mul_f32 v239, 0x3d800000, v239
    v_add_f32 v240, v24, v48
    v_add_f32 v240, v240, v72
    v_add_f32 v240, v240, v96
    v_cvt_pk_bf16_f32 v240, v240, v240
    v_lshlrev_b32 v240, 16, v240
    v_mul_f32 v240, 0x3d800000, v240
    v_add_f32 v241, v26, v50
    v_add_f32 v241, v241, v74
    v_add_f32 v241, v241, v98
    v_cvt_pk_bf16_f32 v241, v241, v241
    v_lshlrev_b32 v241, 16, v241
    v_mul_f32 v241, 0x3d800000, v241
    v_add_f32 v242, v28, v52
    v_add_f32 v242, v242, v76
    v_add_f32 v242, v242, v100
    v_cvt_pk_bf16_f32 v242, v242, v242
    v_lshlrev_b32 v242, 16, v242
    v_mul_f32 v242, 0x3d800000, v242
    v_add_f32 v243, v30, v54
    v_add_f32 v243, v243, v78
    v_add_f32 v243, v243, v102
    v_cvt_pk_bf16_f32 v243, v243, v243
    v_lshlrev_b32 v243, 16, v243
    v_mul_f32 v243, 0x3d800000, v243
    v_cmp_lt_u32 vcc, 1, v2
    v_mov_b32 v248, 0xff800000
    s_nop 1
    v_cndmask_b32 v232, v232, v248, vcc
    v_cndmask_b32 v233, v233, v248, vcc
    v_cndmask_b32 v234, v234, v248, vcc
    v_cndmask_b32 v235, v235, v248, vcc
    v_max_f32 v249, v232, v233
    v_max_f32 v249, v249, v234
    v_max_f32 v249, v249, v235
    v_max_f32 v249, v249, v236
    v_max_f32 v249, v249, v237
    v_max_f32 v249, v249, v238
    v_max_f32 v249, v249, v239
    v_max_f32 v249, v249, v240
    v_max_f32 v249, v249, v241
    v_max_f32 v249, v249, v242
    v_max_f32 v249, v249, v243
    v_and_b32 v247, 63, v0
    v_xor_b32 v244, 16, v247
    v_lshlrev_b32 v244, 2, v244
    v_xor_b32 v245, 32, v247
    v_lshlrev_b32 v245, 2, v245
    ds_bpermute_b32 v248, v244, v249
    s_waitcnt lgkmcnt(0)
    v_max_f32 v249, v249, v248
    ds_bpermute_b32 v248, v245, v249
    s_waitcnt lgkmcnt(0)
    v_max_f32 v249, v249, v248
    v_sub_f32 v232, v232, v249
    v_mul_f32 v232, 0x3fb8aa3b, v232
    v_exp_f32 v232, v232
    v_sub_f32 v233, v233, v249
    v_mul_f32 v233, 0x3fb8aa3b, v233
    v_exp_f32 v233, v233
    v_sub_f32 v234, v234, v249
    v_mul_f32 v234, 0x3fb8aa3b, v234
    v_exp_f32 v234, v234
    v_sub_f32 v235, v235, v249
    v_mul_f32 v235, 0x3fb8aa3b, v235
    v_exp_f32 v235, v235
    v_sub_f32 v236, v236, v249
    v_mul_f32 v236, 0x3fb8aa3b, v236
    v_exp_f32 v236, v236
    v_sub_f32 v237, v237, v249
    v_mul_f32 v237, 0x3fb8aa3b, v237
    v_exp_f32 v237, v237
    v_sub_f32 v238, v238, v249
    v_mul_f32 v238, 0x3fb8aa3b, v238
    v_exp_f32 v238, v238
    v_sub_f32 v239, v239, v249
    v_mul_f32 v239, 0x3fb8aa3b, v239
    v_exp_f32 v239, v239
    v_sub_f32 v240, v240, v249
    v_mul_f32 v240, 0x3fb8aa3b, v240
    v_exp_f32 v240, v240
    v_sub_f32 v241, v241, v249
    v_mul_f32 v241, 0x3fb8aa3b, v241
    v_exp_f32 v241, v241
    v_sub_f32 v242, v242, v249
    v_mul_f32 v242, 0x3fb8aa3b, v242
    v_exp_f32 v242, v242
    v_sub_f32 v243, v243, v249
    v_mul_f32 v243, 0x3fb8aa3b, v243
    v_exp_f32 v243, v243
    s_nop 1
    v_add_f32 v249, v232, v233
    v_add_f32 v249, v249, v234
    v_add_f32 v249, v249, v235
    v_add_f32 v249, v249, v236
    v_add_f32 v249, v249, v237
    v_add_f32 v249, v249, v238
    v_add_f32 v249, v249, v239
    v_add_f32 v249, v249, v240
    v_add_f32 v249, v249, v241
    v_add_f32 v249, v249, v242
    v_add_f32 v249, v249, v243
    ds_bpermute_b32 v248, v244, v249
    s_waitcnt lgkmcnt(0)
    v_add_f32 v249, v249, v248
    ds_bpermute_b32 v248, v245, v249
    s_waitcnt lgkmcnt(0)
    v_add_f32 v249, v249, v248
    v_rcp_f32 v249, v249
    s_nop 1
    v_mul_f32 v232, v232, v249
    v_mul_f32 v233, v233, v249
    v_mul_f32 v234, v234, v249
    v_mul_f32 v235, v235, v249
    v_mul_f32 v236, v236, v249
    v_mul_f32 v237, v237, v249
    v_mul_f32 v238, v238, v249
    v_mul_f32 v239, v239, v249
    v_mul_f32 v240, v240, v249
    v_mul_f32 v241, v241, v249
    v_mul_f32 v242, v242, v249
    v_mul_f32 v243, v243, v249
    v_cmp_gt_u32 vcc, 8, v1
    s_nop 1
    s_and_saveexec_b64 s[76:77], vcc
    v_lshlrev_b32 v247, 7, v1
    v_lshl_add_u32 v247, v2, 3, v247
    v_cvt_pk_bf16_f32 v120, v232, v233
    v_cvt_pk_bf16_f32 v121, v234, v235
    v_cmp_gt_u32 vcc, 2, v2
    s_nop 1
    s_and_saveexec_b64 s[80:81], vcc
    ds_write_b64 v247, v[120:121] offset:11264
    s_or_b64 exec, exec, s[80:81]
    s_nop 1
    v_cvt_pk_bf16_f32 v120, v236, v237
    v_cvt_pk_bf16_f32 v121, v238, v239
    ds_write_b64 v247, v[120:121] offset:11280
    s_nop 1
    v_cvt_pk_bf16_f32 v120, v240, v241
    v_cvt_pk_bf16_f32 v121, v242, v243
    ds_write_b64 v247, v[120:121] offset:11312
    s_nop 1
    s_or_b64 exec, exec, s[76:77]
c0_skipS:
    s_waitcnt lgkmcnt(0)
    s_barrier
    v_lshl_add_u32 v247, v3, 4, v1
    v_mul_u32_u24 v247, 144, v247
    v_lshl_add_u32 v247, v2, 4, v247
    v_and_b32 v6, 7, v1
    v_lshlrev_b32 v248, 7, v6
    v_lshl_add_u32 v248, v2, 4, v248
    ds_read_b128 v[120:123], v247 offset:2048
    ds_read_b128 v[128:131], v248 offset:11264
    ds_read_b128 v[124:127], v247 offset:2112
    ds_read_b128 v[132:135], v248 offset:11328
    v_mov_b32 v232, 0
    v_mov_b32 v233, 0
    v_mov_b32 v234, 0
    v_mov_b32 v235, 0
    s_waitcnt lgkmcnt(0)
    v_mfma_f32_16x16x32_bf16 v[232:235], v[120:123], v[128:131], v[232:235]
    v_mfma_f32_16x16x32_bf16 v[232:235], v[124:127], v[132:135], v[232:235]
    s_nop 7
    v_cvt_pk_bf16_f32 v120, v232, v233
    v_cvt_pk_bf16_f32 v121, v234, v235
    v_cmp_gt_u32 vcc, 8, v1
    s_nop 1
    s_and_saveexec_b64 s[76:77], vcc
    v_lshlrev_b32 v247, 7, v1
    v_lshl_add_u32 v247, v3, 5, v247
    v_lshl_add_u32 v247, v2, 3, v247
    ds_write_b64 v247, v[120:121] offset:12288
    s_or_b64 exec, exec, s[76:77]
    s_waitcnt lgkmcnt(0)
    s_barrier
    ds_read_b128 v[128:131], v248 offset:12288
    ds_read_b128 v[132:135], v248 offset:12352
    v_mov_b32 v8, 0
    v_mov_b32 v9, 0
    v_mov_b32 v10, 0
    v_mov_b32 v11, 0
    v_mov_b32 v12, 0
    v_mov_b32 v13, 0
    v_mov_b32 v14, 0
    v_mov_b32 v15, 0
    v_mov_b32 v16, 0
    v_mov_b32 v17, 0
    v_mov_b32 v18, 0
    v_mov_b32 v19, 0
    v_mov_b32 v20, 0
    v_mov_b32 v21, 0
    v_mov_b32 v22, 0
    v_mov_b32 v23, 0
    v_mov_b32 v24, 0
    v_mov_b32 v25, 0
    v_mov_b32 v26, 0
    v_mov_b32 v27, 0
    v_mov_b32 v28, 0
    v_mov_b32 v29, 0
    v_mov_b32 v30, 0
    v_mov_b32 v31, 0
    v_mov_b32 v32, 0
    v_mov_b32 v33, 0
    v_mov_b32 v34, 0
    v_mov_b32 v35, 0
    s_waitcnt lgkmcnt(0)
    v_mfma_f32_16x16x32_bf16 v[8:11], a[168:171], v[128:131], v[8:11]
    v_mfma_f32_16x16x32_bf16 v[8:11], a[172:175], v[132:135], v[8:11]
    v_mfma_f32_16x16x32_bf16 v[12:15], a[176:179], v[128:131], v[12:15]
    v_mfma_f32_16x16x32_bf16 v[12:15], a[180:183], v[132:135], v[12:15]
    v_mfma_f32_16x16x32_bf16 v[16:19], a[184:187], v[128:131], v[16:19]
    v_mfma_f32_16x16x32_bf16 v[16:19], a[188:191], v[132:135], v[16:19]
    v_mfma_f32_16x16x32_bf16 v[20:23], a[192:195], v[128:131], v[20:23]
    v_mfma_f32_16x16x32_bf16 v[20:23], a[196:199], v[132:135], v[20:23]
    v_mfma_f32_16x16x32_bf16 v[24:27], a[200:203], v[128:131], v[24:27]
    v_mfma_f32_16x16x32_bf16 v[24:27], a[204:207], v[132:135], v[24:27]
    v_mfma_f32_16x16x32_bf16 v[28:31], a[208:211], v[128:131], v[28:31]
    v_mfma_f32_16x16x32_bf16 v[28:31], a[212:215], v[132:135], v[28:31]
    v_mfma_f32_16x16x32_bf16 v[32:35], a[216:219], v[128:131], v[32:35]
    v_mfma_f32_16x16x32_bf16 v[32:35], a[220:223], v[132:135], v[32:35]
    s_nop 7
    s_lshl_b32 s78, s73, 6
    s_add_u32 s79, s78, s2
    s_mul_i32 s79, s79, 28672
    v_cmp_gt_u32 vcc, 8, v1
    s_nop 1
    s_and_saveexec_b64 s[76:77], vcc
    v_mul_u32_u24 v247, 3584, v1
    v_mul_u32_u24 v248, 896, v3
    v_add_u32 v247, v247, v248
    v_lshl_add_u32 v247, v2, 5, v247
    v_mov_b32 v120, v8
    v_mov_b32 v121, s72
    v_mov_b32 v122, v9
    v_mov_b32 v123, s72
    buffer_store_dwordx4 v[120:123], v247, s[24:27], s79 offen offset:0 sc1
    s_nop 2
    v_mov_b32 v120, v10
    v_mov_b32 v121, s72
    v_mov_b32 v122, v11
    v_mov_b32 v123, s72
    buffer_store_dwordx4 v[120:123], v247, s[24:27], s79 offen offset:16 sc1
    s_nop 2
    v_mov_b32 v120, v12
    v_mov_b32 v121, s72
    v_mov_b32 v122, v13
    v_mov_b32 v123, s72
    buffer_store_dwordx4 v[120:123], v247, s[24:27], s79 offen offset:128 sc1
    s_nop 2
    v_mov_b32 v120, v14
    v_mov_b32 v121, s72
    v_mov_b32 v122, v15
    v_mov_b32 v123, s72
    buffer_store_dwordx4 v[120:123], v247, s[24:27], s79 offen offset:144 sc1
    s_nop 2
    v_mov_b32 v120, v16
    v_mov_b32 v121, s72
    v_mov_b32 v122, v17
    v_mov_b32 v123, s72
    buffer_store_dwordx4 v[120:123], v247, s[24:27], s79 offen offset:256 sc1
    s_nop 2
    v_mov_b32 v120, v18
    v_mov_b32 v121, s72
    v_mov_b32 v122, v19
    v_mov_b32 v123, s72
    buffer_store_dwordx4 v[120:123], v247, s[24:27], s79 offen offset:272 sc1
    s_nop 2
    v_mov_b32 v120, v20
    v_mov_b32 v121, s72
    v_mov_b32 v122, v21
    v_mov_b32 v123, s72
    buffer_store_dwordx4 v[120:123], v247, s[24:27], s79 offen offset:384 sc1
    s_nop 2
    v_mov_b32 v120, v22
    v_mov_b32 v121, s72
    v_mov_b32 v122, v23
    v_mov_b32 v123, s72
    buffer_store_dwordx4 v[120:123], v247, s[24:27], s79 offen offset:400 sc1
    s_nop 2
    v_mov_b32 v120, v24
    v_mov_b32 v121, s72
    v_mov_b32 v122, v25
    v_mov_b32 v123, s72
    buffer_store_dwordx4 v[120:123], v247, s[24:27], s79 offen offset:512 sc1
    s_nop 2
    v_mov_b32 v120, v26
    v_mov_b32 v121, s72
    v_mov_b32 v122, v27
    v_mov_b32 v123, s72
    buffer_store_dwordx4 v[120:123], v247, s[24:27], s79 offen offset:528 sc1
    s_nop 2
    v_mov_b32 v120, v28
    v_mov_b32 v121, s72
    v_mov_b32 v122, v29
    v_mov_b32 v123, s72
    buffer_store_dwordx4 v[120:123], v247, s[24:27], s79 offen offset:640 sc1
    s_nop 2
    v_mov_b32 v120, v30
    v_mov_b32 v121, s72
    v_mov_b32 v122, v31
    v_mov_b32 v123, s72
    buffer_store_dwordx4 v[120:123], v247, s[24:27], s79 offen offset:656 sc1
    s_nop 2
    v_mov_b32 v120, v32
    v_mov_b32 v121, s72
    v_mov_b32 v122, v33
    v_mov_b32 v123, s72
    buffer_store_dwordx4 v[120:123], v247, s[24:27], s79 offen offset:768 sc1
    s_nop 2
    v_mov_b32 v120, v34
    v_mov_b32 v121, s72
    v_mov_b32 v122, v35
    v_mov_b32 v123, s72
    buffer_store_dwordx4 v[120:123], v247, s[24:27], s79 offen offset:784 sc1
    s_nop 2
    s_or_b64 exec, exec, s[76:77]
    s_cmp_ge_u32 s2, 56
    s_cbranch_scc1 c0_nored
    s_lshl_b32 s79, s68, 4
    s_add_u32 s79, s79, s78
    s_mul_i32 s79, s79, 28672
    s_lshl_b32 s80, s2, 6
    s_add_u32 s79, s79, s80
    v_and_b32 v247, 31, v0
    v_lshrrev_b32 v248, 2, v247
    v_mul_u32_u24 v248, 3584, v248
    v_and_b32 v247, 3, v247
    v_lshl_add_u32 v247, v247, 4, v248
    s_mov_b32 s33, 0
p2401:
    buffer_load_dwordx4 v[8:11], v247, s[24:27], s79 offen sc1
    s_add_u32 s79, s79, 28672
    buffer_load_dwordx4 v[12:15], v247, s[24:27], s79 offen sc1
    s_add_u32 s79, s79, 28672
    buffer_load_dwordx4 v[16:19], v247, s[24:27], s79 offen sc1
    s_add_u32 s79, s79, 28672
    buffer_load_dwordx4 v[20:23], v247, s[24:27], s79 offen sc1
    s_add_u32 s79, s79, 28672
    buffer_load_dwordx4 v[24:27], v247, s[24:27], s79 offen sc1
    s_add_u32 s79, s79, 28672
    buffer_load_dwordx4 v[28:31], v247, s[24:27], s79 offen sc1
    s_add_u32 s79, s79, 28672
    buffer_load_dwordx4 v[32:35], v247, s[24:27], s79 offen sc1
    s_add_u32 s79, s79, 28672
    buffer_load_dwordx4 v[36:39], v247, s[24:27], s79 offen sc1
    s_add_u32 s79, s79, 28672
    buffer_load_dwordx4 v[40:43], v247, s[24:27], s79 offen sc1
    s_add_u32 s79, s79, 28672
    buffer_load_dwordx4 v[44:47], v247, s[24:27], s79 offen sc1
    s_add_u32 s79, s79, 28672
    buffer_load_dwordx4 v[48:51], v247, s[24:27], s79 offen sc1
    s_add_u32 s79, s79, 28672
    buffer_load_dwordx4 v[52:55], v247, s[24:27], s79 offen sc1
    s_add_u32 s79, s79, 28672
    buffer_load_dwordx4 v[56:59], v247, s[24:27], s79 offen sc1
    s_add_u32 s79, s79, 28672
    buffer_load_dwordx4 v[60:63], v247, s[24:27], s79 offen sc1
    s_add_u32 s79, s79, 28672
    buffer_load_dwordx4 v[64:67], v247, s[24:27], s79 offen sc1
    s_add_u32 s79, s79, 28672
    buffer_load_dwordx4 v[68:71], v247, s[24:27], s79 offen sc1
    s_add_u32 s79, s79, 28672
    s_sub_u32 s79, s79, 458752
    s_waitcnt vmcnt(0)
    v_xor_b32 v250, s72, v9
    v_xor_b32 v251, s72, v11
    v_or_b32 v250, v250, v251
    v_xor_b32 v251, s72, v13
    v_or_b32 v250, v250, v251
    v_xor_b32 v251, s72, v15
    v_or_b32 v250, v250, v251
    v_xor_b32 v251, s72, v17
    v_or_b32 v250, v250, v251
    v_xor_b32 v251, s72, v19
    v_or_b32 v250, v250, v251
    v_xor_b32 v251, s72, v21
    v_or_b32 v250, v250, v251
    v_xor_b32 v251, s72, v23
    v_or_b32 v250, v250, v251
    v_xor_b32 v251, s72, v25
    v_or_b32 v250, v250, v251
    v_xor_b32 v251, s72, v27
    v_or_b32 v250, v250, v251
    v_xor_b32 v251, s72, v29
    v_or_b32 v250, v250, v251
    v_xor_b32 v251, s72, v31
    v_or_b32 v250, v250, v251
    v_xor_b32 v251, s72, v33
    v_or_b32 v250, v250, v251
    v_xor_b32 v251, s72, v35
    v_or_b32 v250, v250, v251
    v_xor_b32 v251, s72, v37
    v_or_b32 v250, v250, v251
    v_xor_b32 v251, s72, v39
    v_or_b32 v250, v250, v251
    v_xor_b32 v251, s72, v41
    v_or_b32 v250, v250, v251
    v_xor_b32 v251, s72, v43
    v_or_b32 v250, v250, v251
    v_xor_b32 v251, s72, v45
    v_or_b32 v250, v250, v251
    v_xor_b32 v251, s72, v47
    v_or_b32 v250, v250, v251
    v_xor_b32 v251, s72, v49
    v_or_b32 v250, v250, v251
    v_xor_b32 v251, s72, v51
    v_or_b32 v250, v250, v251
    v_xor_b32 v251, s72, v53
    v_or_b32 v250, v250, v251
    v_xor_b32 v251, s72, v55
    v_or_b32 v250, v250, v251
    v_xor_b32 v251, s72, v57
    v_or_b32 v250, v250, v251
    v_xor_b32 v251, s72, v59
    v_or_b32 v250, v250, v251
    v_xor_b32 v251, s72, v61
    v_or_b32 v250, v250, v251
    v_xor_b32 v251, s72, v63
    v_or_b32 v250, v250, v251
    v_xor_b32 v251, s72, v65
    v_or_b32 v250, v250, v251
    v_xor_b32 v251, s72, v67
    v_or_b32 v250, v250, v251
    v_xor_b32 v251, s72, v69
    v_or_b32 v250, v250, v251
    v_xor_b32 v251, s72, v71
    v_or_b32 v250, v250, v251
    v_cmp_ne_u32 vcc, 0, v250
    s_add_u32 s33, s33, 1
    s_cmp_gt_u32 s33, 400000
    s_cbranch_scc1 p2401x
    s_nop 3
    s_cbranch_vccnz p2401
p2401x:
    v_add_f32 v8, v8, v12
    v_add_f32 v10, v10, v14
    v_add_f32 v8, v8, v16
    v_add_f32 v10, v10, v18
    v_add_f32 v8, v8, v20
    v_add_f32 v10, v10, v22
    v_add_f32 v8, v8, v24
    v_add_f32 v10, v10, v26
    v_add_f32 v8, v8, v28
    v_add_f32 v10, v10, v30
    v_add_f32 v8, v8, v32
    v_add_f32 v10, v10, v34
    v_add_f32 v8, v8, v36
    v_add_f32 v10, v10, v38
    v_add_f32 v8, v8, v40
    v_add_f32 v10, v10, v42
    v_add_f32 v8, v8, v44
    v_add_f32 v10, v10, v46
    v_add_f32 v8, v8, v48
    v_add_f32 v10, v10, v50
    v_add_f32 v8, v8, v52
    v_add_f32 v10, v10, v54
    v_add_f32 v8, v8, v56
    v_add_f32 v10, v10, v58
    v_add_f32 v8, v8, v60
    v_add_f32 v10, v10, v62
    v_add_f32 v8, v8, v64
    v_add_f32 v10, v10, v66
    v_add_f32 v8, v8, v68
    v_add_f32 v10, v10, v70
    v_mov_b32 v9, v10
    v_and_b32 v248, 31, v0
    v_lshlrev_b32 v248, 3, v248
    v_lshl_add_u32 v248, v3, 8, v248
    ds_write_b64 v248, v[8:9] offset:13312
    s_waitcnt lgkmcnt(0)
c0_nored:
    s_barrier
    s_cmp_ge_u32 s2, 56
    s_cbranch_scc1 c0_nored2
    v_and_b32 v248, 31, v0
    v_lshlrev_b32 v248, 3, v248
    ds_read_b64 v[8:9], v248 offset:13312
    ds_read_b64 v[10:11], v248 offset:13568
    ds_read_b64 v[12:13], v248 offset:13824
    ds_read_b64 v[14:15], v248 offset:14080
    s_waitcnt lgkmcnt(0)
    v_add_f32 v8, v8, v10
    v_add_f32 v9, v9, v11
    v_add_f32 v8, v8, v12
    v_add_f32 v9, v9, v13
    v_add_f32 v8, v8, v14
    v_add_f32 v9, v9, v15
    v_cvt_pk_bf16_f32 v8, v8, v9
    v_mov_b32 v9, s72
    v_and_b32 v247, 31, v0
    v_lshrrev_b32 v248, 2, v247
    v_mul_u32_u24 v248, 1792, v248
    v_and_b32 v247, 3, v247
    v_lshl_add_u32 v247, v247, 3, v248
    s_mul_i32 s79, s73, 14336
    s_lshl_b32 s80, s2, 5
    s_add_u32 s79, s79, s80
    buffer_store_dwordx2 v[8:9], v247, s[28:31], s79 offen sc1
c0_nored2:
    s_mul_i32 s79, s73, 14336
    v_and_b32 v6, 7, v1
    v_mul_u32_u24 v247, 1792, v6
    v_lshl_add_u32 v247, v2, 5, v247
    s_cmp_eq_u32 s71, 63
    s_cbranch_scc1 c0_end
    s_mov_b32 s33, 0
p2578:
    buffer_load_dwordx4 v[8:11], v247, s[28:31], s79 offen offset:0 sc1
    buffer_load_dwordx4 v[12:15], v247, s[28:31], s79 offen offset:16 sc1
    buffer_load_dwordx4 v[16:19], v247, s[28:31], s79 offen offset:128 sc1
    buffer_load_dwordx4 v[20:23], v247, s[28:31], s79 offen offset:144 sc1
    buffer_load_dwordx4 v[24:27], v247, s[28:31], s79 offen offset:256 sc1
    buffer_load_dwordx4 v[28:31], v247, s[28:31], s79 offen offset:272 sc1
    buffer_load_dwordx4 v[32:35], v247, s[28:31], s79 offen offset:384 sc1
    buffer_load_dwordx4 v[36:39], v247, s[28:31], s79 offen offset:400 sc1
    buffer_load_dwordx4 v[40:43], v247, s[28:31], s79 offen offset:512 sc1
    buffer_load_dwordx4 v[44:47], v247, s[28:31], s79 offen offset:528 sc1
    buffer_load_dwordx4 v[48:51], v247, s[28:31], s79 offen offset:640 sc1
    buffer_load_dwordx4 v[52:55], v247, s[28:31], s79 offen offset:656 sc1
    buffer_load_dwordx4 v[56:59], v247, s[28:31], s79 offen offset:768 sc1
    buffer_load_dwordx4 v[60:63], v247, s[28:31], s79 offen offset:784 sc1
    buffer_load_dwordx4 v[64:67], v247, s[28:31], s79 offen offset:896 sc1
    buffer_load_dwordx4 v[68:71], v247, s[28:31], s79 offen offset:912 sc1
    buffer_load_dwordx4 v[72:75], v247, s[28:31], s79 offen offset:1024 sc1
    buffer_load_dwordx4 v[76:79], v247, s[28:31], s79 offen offset:1040 sc1
    buffer_load_dwordx4 v[80:83], v247, s[28:31], s79 offen offset:1152 sc1
    buffer_load_dwordx4 v[84:87], v247, s[28:31], s79 offen offset:1168 sc1
    buffer_load_dwordx4 v[88:91], v247, s[28:31], s79 offen offset:1280 sc1
    buffer_load_dwordx4 v[92:95], v247, s[28:31], s79 offen offset:1296 sc1
    buffer_load_dwordx4 v[96:99], v247, s[28:31], s79 offen offset:1408 sc1
    buffer_load_dwordx4 v[100:103], v247, s[28:31], s79 offen offset:1424 sc1
    buffer_load_dwordx4 v[104:107], v247, s[28:31], s79 offen offset:1536 sc1
    buffer_load_dwordx4 v[108:111], v247, s[28:31], s79 offen offset:1552 sc1
    buffer_load_dwordx4 v[112:115], v247, s[28:31], s79 offen offset:1664 sc1
    buffer_load_dwordx4 v[116:119], v247, s[28:31], s79 offen offset:1680 sc1
    s_waitcnt vmcnt(0)
    v_xor_b32 v250, s72, v9
    v_xor_b32 v251, s72, v11
    v_or_b32 v250, v250, v251
    v_xor_b32 v251, s72, v13
    v_or_b32 v250, v250, v251
    v_xor_b32 v251, s72, v15
    v_or_b32 v250, v250, v251
    v_xor_b32 v251, s72, v17
    v_or_b32 v250, v250, v251
    v_xor_b32 v251, s72, v19
    v_or_b32 v250, v250, v251
    v_xor_b32 v251, s72, v21
    v_or_b32 v250, v250, v251
    v_xor_b32 v251, s72, v23
    v_or_b32 v250, v250, v251
    v_xor_b32 v251, s72, v25
    v_or_b32 v250, v250, v251
    v_xor_b32 v251, s72, v27
    v_or_b32 v250, v250, v251
    v_xor_b32 v251, s72, v29
    v_or_b32 v250, v250, v251
    v_xor_b32 v251, s72, v31
    v_or_b32 v250, v250, v251
    v_xor_b32 v251, s72, v33
    v_or_b32 v250, v250, v251
    v_xor_b32 v251, s72, v35
    v_or_b32 v250, v250, v251
    v_xor_b32 v251, s72, v37
    v_or_b32 v250, v250, v251
    v_xor_b32 v251, s72, v39
    v_or_b32 v250, v250, v251
    v_xor_b32 v251, s72, v41
    v_or_b32 v250, v250, v251
    v_xor_b32 v251, s72, v43
    v_or_b32 v250, v250, v251
    v_xor_b32 v251, s72, v45
    v_or_b32 v250, v250, v251
    v_xor_b32 v251, s72, v47
    v_or_b32 v250, v250, v251
    v_xor_b32 v251, s72, v49
    v_or_b32 v250, v250, v251
    v_xor_b32 v251, s72, v51
    v_or_b32 v250, v250, v251
    v_xor_b32 v251, s72, v53
    v_or_b32 v250, v250, v251
    v_xor_b32 v251, s72, v55
    v_or_b32 v250, v250, v251
    v_xor_b32 v251, s72, v57
    v_or_b32 v250, v250, v251
    v_xor_b32 v251, s72, v59
    v_or_b32 v250, v250, v251
    v_xor_b32 v251, s72, v61
    v_or_b32 v250, v250, v251
    v_xor_b32 v251, s72, v63
    v_or_b32 v250, v250, v251
    v_xor_b32 v251, s72, v65
    v_or_b32 v250, v250, v251
    v_xor_b32 v251, s72, v67
    v_or_b32 v250, v250, v251
    v_xor_b32 v251, s72, v69
    v_or_b32 v250, v250, v251
    v_xor_b32 v251, s72, v71
    v_or_b32 v250, v250, v251
    v_xor_b32 v251, s72, v73
    v_or_b32 v250, v250, v251
    v_xor_b32 v251, s72, v75
    v_or_b32 v250, v250, v251
    v_xor_b32 v251, s72, v77
    v_or_b32 v250, v250, v251
    v_xor_b32 v251, s72, v79
    v_or_b32 v250, v250, v251
    v_xor_b32 v251, s72, v81
    v_or_b32 v250, v250, v251
    v_xor_b32 v251, s72, v83
    v_or_b32 v250, v250, v251
    v_xor_b32 v251, s72, v85
    v_or_b32 v250, v250, v251
    v_xor_b32 v251, s72, v87
    v_or_b32 v250, v250, v251
    v_xor_b32 v251, s72, v89
    v_or_b32 v250, v250, v251
    v_xor_b32 v251, s72, v91
    v_or_b32 v250, v250, v251
    v_xor_b32 v251, s72, v93
    v_or_b32 v250, v250, v251
    v_xor_b32 v251, s72, v95
    v_or_b32 v250, v250, v251
    v_xor_b32 v251, s72, v97
    v_or_b32 v250, v250, v251
    v_xor_b32 v251, s72, v99
    v_or_b32 v250, v250, v251
    v_xor_b32 v251, s72, v101
    v_or_b32 v250, v250, v251
    v_xor_b32 v251, s72, v103
    v_or_b32 v250, v250, v251
    v_xor_b32 v251, s72, v105
    v_or_b32 v250, v250, v251
    v_xor_b32 v251, s72, v107
    v_or_b32 v250, v250, v251
    v_xor_b32 v251, s72, v109
    v_or_b32 v250, v250, v251
    v_xor_b32 v251, s72, v111
    v_or_b32 v250, v250, v251
    v_xor_b32 v251, s72, v113
    v_or_b32 v250, v250, v251
    v_xor_b32 v251, s72, v115
    v_or_b32 v250, v250, v251
    v_xor_b32 v251, s72, v117
    v_or_b32 v250, v250, v251
    v_xor_b32 v251, s72, v119
    v_or_b32 v250, v250, v251
    v_cmp_ne_u32 vcc, 0, v250
    s_add_u32 s33, s33, 1
    s_cmp_gt_u32 s33, 400000
    s_cbranch_scc1 p2578x
    s_nop 3
    s_cbranch_vccnz p2578
p2578x:
    v_mov_b32 v176, v8
    v_mov_b32 v177, v10
    v_mov_b32 v178, v12
    v_mov_b32 v179, v14
    v_mov_b32 v180, v16
    v_mov_b32 v181, v18
    v_mov_b32 v182, v20
    v_mov_b32 v183, v22
    v_mov_b32 v184, v24
    v_mov_b32 v185, v26
    v_mov_b32 v186, v28
    v_mov_b32 v187, v30
    v_mov_b32 v188, v32
    v_mov_b32 v189, v34
    v_mov_b32 v190, v36
    v_mov_b32 v191, v38
    v_mov_b32 v192, v40
    v_mov_b32 v193, v42
    v_mov_b32 v194, v44
    v_mov_b32 v195, v46
    v_mov_b32 v196, v48
    v_mov_b32 v197, v50
    v_mov_b32 v198, v52
    v_mov_b32 v199, v54
    v_mov_b32 v200, v56
    v_mov_b32 v201, v58
    v_mov_b32 v202, v60
    v_mov_b32 v203, v62
    v_mov_b32 v204, v64
    v_mov_b32 v205, v66
    v_mov_b32 v206, v68
    v_mov_b32 v207, v70
    v_mov_b32 v208, v72
    v_mov_b32 v209, v74
    v_mov_b32 v210, v76
    v_mov_b32 v211, v78
    v_mov_b32 v212, v80
    v_mov_b32 v213, v82
    v_mov_b32 v214, v84
    v_mov_b32 v215, v86
    v_mov_b32 v216, v88
    v_mov_b32 v217, v90
    v_mov_b32 v218, v92
    v_mov_b32 v219, v94
    v_mov_b32 v220, v96
    v_mov_b32 v221, v98
    v_mov_b32 v222, v100
    v_mov_b32 v223, v102
    v_mov_b32 v224, v104
    v_mov_b32 v225, v106
    v_mov_b32 v226, v108
    v_mov_b32 v227, v110
    v_mov_b32 v228, v112
    v_mov_b32 v229, v114
    v_mov_b32 v230, v116
    v_mov_b32 v231, v118
    s_add_u32 s71, s71, 1
    s_branch c0_loop
c0_end:
    s_endpgm
.globl attn_kernel
.p2align 8
.type attn_kernel,@function
attn_kernel:
    s_load_dwordx16 s[36:51], s[0:1], 0
    s_load_dwordx8 s[52:59], s[0:1], 64
    s_load_dwordx2 s[60:61], s[0:1], 104
    s_load_dwordx2 s[62:63], s[0:1], 120
    s_waitcnt lgkmcnt(0)
    s_cmp_ge_u32 s2, 1024
    s_cbranch_scc1 at_end
    s_add_u32 s12, s62, 33554432
    s_addc_u32 s13, s63, 0
    s_mov_b32 s14, 50331648
    s_mov_b32 s15, 0x20000
    s_add_u32 s16, s62, 119537664
    s_addc_u32 s17, s63, 0
    s_mov_b32 s18, 8388608
    s_mov_b32 s19, 0x20000
    s_add_u32 s20, s62, 100663296
    s_addc_u32 s21, s63, 0
    s_mov_b32 s22, 16777216
    s_mov_b32 s23, 0x20000
    s_lshr_b32 s4, s2, 4
    s_and_b32 s5, s2, 15
    s_lshl_b32 s5, s5, 9
    s_mul_i32 s6, s4, 786432
    s_add_u32 s6, s6, s5
    s_lshl_b32 s7, s4, 17
    s_add_u32 s7, s7, s5
    v_and_b32 v1, 15, v0
    v_bfe_u32 v2, v0, 4, 2
    v_lshrrev_b32 v3, 6, v0
    v_mov_b32 v8, 0
    v_mov_b32 v9, 0
    v_mov_b32 v10, 0
    v_mov_b32 v11, 0
    v_lshlrev_b32 v5, 4, v0
    ds_write_b128 v5, v[8:11] offset:0
    ds_write_b128 v5, v[8:11] offset:4096
    ds_write_b128 v5, v[8:11] offset:8192
    ds_write_b128 v5, v[8:11] offset:12288
    ds_write_b128 v5, v[8:11] offset:16384
    ds_write_b128 v5, v[8:11] offset:20480
    ds_write_b128 v5, v[8:11] offset:24576
    ds_write_b128 v5, v[8:11] offset:28672
    ds_write_b128 v5, v[8:11] offset:32768
    ds_write_b128 v5, v[8:11] offset:36864
    v_lshrrev_b32 v4, 5, v0
    v_and_b32 v5, 31, v0
    v_mul_u32_u24 v6, 24576, v4
    v_lshl_add_u32 v6, v5, 4, v6
    v_add_u32 v6, 16384, v6
    v_lshlrev_b32 v7, 14, v4
    v_lshl_add_u32 v7, v5, 4, v7
    v_add_u32 v7, 8192, v7
    buffer_load_dwordx4 v[16:19], v7, s[16:19], s7 offen
    buffer_load_dwordx4 v[20:23], v6, s[12:15], s6 offen
    v_add_u32 v6, 196608, v6
    buffer_load_dwordx4 v[24:27], v6, s[12:15], s6 offen
    v_add_u32 v6, 196608, v6
    buffer_load_dwordx4 v[28:31], v6, s[12:15], s6 offen
    v_add_u32 v6, 196608, v6
    buffer_load_dwordx4 v[32:35], v6, s[12:15], s6 offen
    v_add_u32 v6, 196608, v6
    v_mul_u32_u24 v7, 1152, v5
    v_lshl_add_u32 v7, v4, 1, v7
    s_waitcnt lgkmcnt(0)
    s_barrier
    s_waitcnt vmcnt(0)
    ds_write_b16 v7, v16 offset:0
    ds_write_b16_d16_hi v7, v16 offset:144
    ds_write_b16 v7, v17 offset:288
    ds_write_b16_d16_hi v7, v17 offset:432
    ds_write_b16 v7, v18 offset:576
    ds_write_b16_d16_hi v7, v18 offset:720
    ds_write_b16 v7, v19 offset:864
    ds_write_b16_d16_hi v7, v19 offset:1008
    ds_write_b16 v7, v20 offset:16
    ds_write_b16_d16_hi v7, v20 offset:160
    ds_write_b16 v7, v21 offset:304
    ds_write_b16_d16_hi v7, v21 offset:448
    ds_write_b16 v7, v22 offset:592
    ds_write_b16_d16_hi v7, v22 offset:736
    ds_write_b16 v7, v23 offset:880
    ds_write_b16_d16_hi v7, v23 offset:1024
    ds_write_b16 v7, v24 offset:32
    ds_write_b16_d16_hi v7, v24 offset:176
    ds_write_b16 v7, v25 offset:320
    ds_write_b16_d16_hi v7, v25 offset:464
    ds_write_b16 v7, v26 offset:608
    ds_write_b16_d16_hi v7, v26 offset:752
    ds_write_b16 v7, v27 offset:896
    ds_write_b16_d16_hi v7, v27 offset:1040
    ds_write_b16 v7, v28 offset:48
    ds_write_b16_d16_hi v7, v28 offset:192
    ds_write_b16 v7, v29 offset:336
    ds_write_b16_d16_hi v7, v29 offset:480
    ds_write_b16 v7, v30 offset:624
    ds_write_b16_d16_hi v7, v30 offset:768
    ds_write_b16 v7, v31 offset:912
    ds_write_b16_d16_hi v7, v31 offset:1056
    ds_write_b16 v7, v32 offset:64
    ds_write_b16_d16_hi v7, v32 offset:208
    ds_write_b16 v7, v33 offset:352
    ds_write_b16_d16_hi v7, v33 offset:496
    ds_write_b16 v7, v34 offset:640
    ds_write_b16_d16_hi v7, v34 offset:784
    ds_write_b16 v7, v35 offset:928
    ds_write_b16_d16_hi v7, v35 offset:1072
    s_nop 1
    v_readfirstlane_b32 s8, v3
    s_cmp_ge_u32 s8, 2
    s_cbranch_scc1 at_skip
    v_lshl_add_u32 v4, v3, 4, v1
    v_mul_u32_u24 v6, 24576, v4
    v_lshl_add_u32 v6, v2, 4, v6
    v_and_b32 v7, 7, v1
    v_lshlrev_b32 v7, 14, v7
    v_lshl_add_u32 v7, v2, 4, v7
    v_mul_u32_u24 v12, 24576, v1
    v_lshl_add_u32 v12, v2, 4, v12
    v_add_u32 v12, 8192, v12
    v_add_u32 v13, 393216, v12
    v_mov_b32 v32, 0
    v_mov_b32 v33, 0
    v_mov_b32 v34, 0
    v_mov_b32 v35, 0
    v_mov_b32 v36, 0
    v_mov_b32 v37, 0
    v_mov_b32 v38, 0
    v_mov_b32 v39, 0
    v_mov_b32 v40, 0
    v_mov_b32 v41, 0
    v_mov_b32 v42, 0
    v_mov_b32 v43, 0
    buffer_load_dwordx4 v[16:19], v6, s[12:15], s6 offen offset:0
    buffer_load_dwordx4 v[20:23], v7, s[16:19], s7 offen offset:0
    buffer_load_dwordx4 v[24:27], v12, s[12:15], s6 offen offset:0
    buffer_load_dwordx4 v[28:31], v13, s[12:15], s6 offen offset:0
    s_waitcnt vmcnt(0)
    v_mfma_f32_16x16x32_bf16 v[32:35], v[20:23], v[16:19], v[32:35]
    v_mfma_f32_16x16x32_bf16 v[36:39], v[24:27], v[16:19], v[36:39]
    v_mfma_f32_16x16x32_bf16 v[40:43], v[28:31], v[16:19], v[40:43]
    buffer_load_dwordx4 v[16:19], v6, s[12:15], s6 offen offset:64
    buffer_load_dwordx4 v[20:23], v7, s[16:19], s7 offen offset:64
    buffer_load_dwordx4 v[24:27], v12, s[12:15], s6 offen offset:64
    buffer_load_dwordx4 v[28:31], v13, s[12:15], s6 offen offset:64
    s_waitcnt vmcnt(0)
    v_mfma_f32_16x16x32_bf16 v[32:35], v[20:23], v[16:19], v[32:35]
    v_mfma_f32_16x16x32_bf16 v[36:39], v[24:27], v[16:19], v[36:39]
    v_mfma_f32_16x16x32_bf16 v[40:43], v[28:31], v[16:19], v[40:43]
    buffer_load_dwordx4 v[16:19], v6, s[12:15], s6 offen offset:128
    buffer_load_dwordx4 v[20:23], v7, s[16:19], s7 offen offset:128
    buffer_load_dwordx4 v[24:27], v12, s[12:15], s6 offen offset:128
    buffer_load_dwordx4 v[28:31], v13, s[12:15], s6 offen offset:128
    s_waitcnt vmcnt(0)
    v_mfma_f32_16x16x32_bf16 v[32:35], v[20:23], v[16:19], v[32:35]
    v_mfma_f32_16x16x32_bf16 v[36:39], v[24:27], v[16:19], v[36:39]
    v_mfma_f32_16x16x32_bf16 v[40:43], v[28:31], v[16:19], v[40:43]
    buffer_load_dwordx4 v[16:19], v6, s[12:15], s6 offen offset:192
    buffer_load_dwordx4 v[20:23], v7, s[16:19], s7 offen offset:192
    buffer_load_dwordx4 v[24:27], v12, s[12:15], s6 offen offset:192
    buffer_load_dwordx4 v[28:31], v13, s[12:15], s6 offen offset:192
    s_waitcnt vmcnt(0)
    v_mfma_f32_16x16x32_bf16 v[32:35], v[20:23], v[16:19], v[32:35]
    v_mfma_f32_16x16x32_bf16 v[36:39], v[24:27], v[16:19], v[36:39]
    v_mfma_f32_16x16x32_bf16 v[40:43], v[28:31], v[16:19], v[40:43]
    buffer_load_dwordx4 v[16:19], v6, s[12:15], s6 offen offset:256
    buffer_load_dwordx4 v[20:23], v7, s[16:19], s7 offen offset:256
    buffer_load_dwordx4 v[24:27], v12, s[12:15], s6 offen offset:256
    buffer_load_dwordx4 v[28:31], v13, s[12:15], s6 offen offset:256
    s_waitcnt vmcnt(0)
    v_mfma_f32_16x16x32_bf16 v[32:35], v[20:23], v[16:19], v[32:35]
    v_mfma_f32_16x16x32_bf16 v[36:39], v[24:27], v[16:19], v[36:39]
    v_mfma_f32_16x16x32_bf16 v[40:43], v[28:31], v[16:19], v[40:43]
    buffer_load_dwordx4 v[16:19], v6, s[12:15], s6 offen offset:320
    buffer_load_dwordx4 v[20:23], v7, s[16:19], s7 offen offset:320
    buffer_load_dwordx4 v[24:27], v12, s[12:15], s6 offen offset:320
    buffer_load_dwordx4 v[28:31], v13, s[12:15], s6 offen offset:320
    s_waitcnt vmcnt(0)
    v_mfma_f32_16x16x32_bf16 v[32:35], v[20:23], v[16:19], v[32:35]
    v_mfma_f32_16x16x32_bf16 v[36:39], v[24:27], v[16:19], v[36:39]
    v_mfma_f32_16x16x32_bf16 v[40:43], v[28:31], v[16:19], v[40:43]
    buffer_load_dwordx4 v[16:19], v6, s[12:15], s6 offen offset:384
    buffer_load_dwordx4 v[20:23], v7, s[16:19], s7 offen offset:384
    buffer_load_dwordx4 v[24:27], v12, s[12:15], s6 offen offset:384
    buffer_load_dwordx4 v[28:31], v13, s[12:15], s6 offen offset:384
    s_waitcnt vmcnt(0)
    v_mfma_f32_16x16x32_bf16 v[32:35], v[20:23], v[16:19], v[32:35]
    v_mfma_f32_16x16x32_bf16 v[36:39], v[24:27], v[16:19], v[36:39]
    v_mfma_f32_16x16x32_bf16 v[40:43], v[28:31], v[16:19], v[40:43]
    buffer_load_dwordx4 v[16:19], v6, s[12:15], s6 offen offset:448
    buffer_load_dwordx4 v[20:23], v7, s[16:19], s7 offen offset:448
    buffer_load_dwordx4 v[24:27], v12, s[12:15], s6 offen offset:448
    buffer_load_dwordx4 v[28:31], v13, s[12:15], s6 offen offset:448
    s_waitcnt vmcnt(0)
    v_mfma_f32_16x16x32_bf16 v[32:35], v[20:23], v[16:19], v[32:35]
    v_mfma_f32_16x16x32_bf16 v[36:39], v[24:27], v[16:19], v[36:39]
    v_mfma_f32_16x16x32_bf16 v[40:43], v[28:31], v[16:19], v[40:43]
    s_nop 7
    v_mov_b32 v48, 0xff800000
    v_cvt_pk_bf16_f32 v32, v32, v32
    v_lshlrev_b32 v32, 16, v32
    v_mul_f32 v32, 0x3d800000, v32
    v_cvt_pk_bf16_f32 v33, v33, v33
    v_lshlrev_b32 v33, 16, v33
    v_mul_f32 v33, 0x3d800000, v33
    v_cvt_pk_bf16_f32 v34, v34, v34
    v_lshlrev_b32 v34, 16, v34
    v_mul_f32 v34, 0x3d800000, v34
    v_cvt_pk_bf16_f32 v35, v35, v35
    v_lshlrev_b32 v35, 16, v35
    v_mul_f32 v35, 0x3d800000, v35
    v_cvt_pk_bf16_f32 v36, v36, v36
    v_lshlrev_b32 v36, 16, v36
    v_mul_f32 v36, 0x3d800000, v36
    v_cvt_pk_bf16_f32 v37, v37, v37
    v_lshlrev_b32 v37, 16, v37
    v_mul_f32 v37, 0x3d800000, v37
    v_cvt_pk_bf16_f32 v38, v38, v38
    v_lshlrev_b32 v38, 16, v38
    v_mul_f32 v38, 0x3d800000, v38
    v_cvt_pk_bf16_f32 v39, v39, v39
    v_lshlrev_b32 v39, 16, v39
    v_mul_f32 v39, 0x3d800000, v39
    v_cvt_pk_bf16_f32 v40, v40, v40
    v_lshlrev_b32 v40, 16, v40
    v_mul_f32 v40, 0x3d800000, v40
    v_cvt_pk_bf16_f32 v41, v41, v41
    v_lshlrev_b32 v41, 16, v41
    v_mul_f32 v41, 0x3d800000, v41
    v_cvt_pk_bf16_f32 v42, v42, v42
    v_lshlrev_b32 v42, 16, v42
    v_mul_f32 v42, 0x3d800000, v42
    v_cvt_pk_bf16_f32 v43, v43, v43
    v_lshlrev_b32 v43, 16, v43
    v_mul_f32 v43, 0x3d800000, v43
    v_cmp_lt_u32 vcc, 1, v2
    s_nop 1
    v_cndmask_b32 v32, v32, v48, vcc
    v_cndmask_b32 v33, v33, v48, vcc
    v_cndmask_b32 v34, v34, v48, vcc
    v_cndmask_b32 v35, v35, v48, vcc
    v_lshl_add_u32 v49, v2, 2, 0
    v_cmp_gt_u32 vcc, v49, v4
    s_nop 1
    v_cndmask_b32 v36, v36, v48, vcc
    v_lshl_add_u32 v49, v2, 2, 1
    v_cmp_gt_u32 vcc, v49, v4
    s_nop 1
    v_cndmask_b32 v37, v37, v48, vcc
    v_lshl_add_u32 v49, v2, 2, 2
    v_cmp_gt_u32 vcc, v49, v4
    s_nop 1
    v_cndmask_b32 v38, v38, v48, vcc
    v_lshl_add_u32 v49, v2, 2, 3
    v_cmp_gt_u32 vcc, v49, v4
    s_nop 1
    v_cndmask_b32 v39, v39, v48, vcc
    v_lshl_add_u32 v49, v2, 2, 16
    v_cmp_gt_u32 vcc, v49, v4
    s_nop 1
    v_cndmask_b32 v40, v40, v48, vcc
    v_lshl_add_u32 v49, v2, 2, 17
    v_cmp_gt_u32 vcc, v49, v4
    s_nop 1
    v_cndmask_b32 v41, v41, v48, vcc
    v_lshl_add_u32 v49, v2, 2, 18
    v_cmp_gt_u32 vcc, v49, v4
    s_nop 1
    v_cndmask_b32 v42, v42, v48, vcc
    v_lshl_add_u32 v49, v2, 2, 19
    v_cmp_gt_u32 vcc, v49, v4
    s_nop 1
    v_cndmask_b32 v43, v43, v48, vcc
    v_max_f32 v49, v32, v33
    v_max_f32 v49, v49, v34
    v_max_f32 v49, v49, v35
    v_max_f32 v49, v49, v36
    v_max_f32 v49, v49, v37
    v_max_f32 v49, v49, v38
    v_max_f32 v49, v49, v39
    v_max_f32 v49, v49, v40
    v_max_f32 v49, v49, v41
    v_max_f32 v49, v49, v42
    v_max_f32 v49, v49, v43
    v_and_b32 v50, 63, v0
    v_xor_b32 v51, 16, v50
    v_lshlrev_b32 v51, 2, v51
    v_xor_b32 v52, 32, v50
    v_lshlrev_b32 v52, 2, v52
    ds_bpermute_b32 v48, v51, v49
    s_waitcnt lgkmcnt(0)
    v_max_f32 v49, v49, v48
    ds_bpermute_b32 v48, v52, v49
    s_waitcnt lgkmcnt(0)
    v_max_f32 v49, v49, v48
    v_sub_f32 v32, v32, v49
    v_mul_f32 v32, 0x3fb8aa3b, v32
    v_exp_f32 v32, v32
    v_sub_f32 v33, v33, v49
    v_mul_f32 v33, 0x3fb8aa3b, v33
    v_exp_f32 v33, v33
    v_sub_f32 v34, v34, v49
    v_mul_f32 v34, 0x3fb8aa3b, v34
    v_exp_f32 v34, v34
    v_sub_f32 v35, v35, v49
    v_mul_f32 v35, 0x3fb8aa3b, v35
    v_exp_f32 v35, v35
    v_sub_f32 v36, v36, v49
    v_mul_f32 v36, 0x3fb8aa3b, v36
    v_exp_f32 v36, v36
    v_sub_f32 v37, v37, v49
    v_mul_f32 v37, 0x3fb8aa3b, v37
    v_exp_f32 v37, v37
    v_sub_f32 v38, v38, v49
    v_mul_f32 v38, 0x3fb8aa3b, v38
    v_exp_f32 v38, v38
    v_sub_f32 v39, v39, v49
    v_mul_f32 v39, 0x3fb8aa3b, v39
    v_exp_f32 v39, v39
    v_sub_f32 v40, v40, v49
    v_mul_f32 v40, 0x3fb8aa3b, v40
    v_exp_f32 v40, v40
    v_sub_f32 v41, v41, v49
    v_mul_f32 v41, 0x3fb8aa3b, v41
    v_exp_f32 v41, v41
    v_sub_f32 v42, v42, v49
    v_mul_f32 v42, 0x3fb8aa3b, v42
    v_exp_f32 v42, v42
    v_sub_f32 v43, v43, v49
    v_mul_f32 v43, 0x3fb8aa3b, v43
    v_exp_f32 v43, v43
    s_nop 1
    v_add_f32 v49, v32, v33
    v_add_f32 v49, v49, v34
    v_add_f32 v49, v49, v35
    v_add_f32 v49, v49, v36
    v_add_f32 v49, v49, v37
    v_add_f32 v49, v49, v38
    v_add_f32 v49, v49, v39
    v_add_f32 v49, v49, v40
    v_add_f32 v49, v49, v41
    v_add_f32 v49, v49, v42
    v_add_f32 v49, v49, v43
    ds_bpermute_b32 v48, v51, v49
    s_waitcnt lgkmcnt(0)
    v_add_f32 v49, v49, v48
    ds_bpermute_b32 v48, v52, v49
    s_waitcnt lgkmcnt(0)
    v_add_f32 v49, v49, v48
    v_rcp_f32 v49, v49
    s_nop 1
    v_mul_f32 v32, v32, v49
    v_mul_f32 v33, v33, v49
    v_mul_f32 v34, v34, v49
    v_mul_f32 v35, v35, v49
    v_mul_f32 v36, v36, v49
    v_mul_f32 v37, v37, v49
    v_mul_f32 v38, v38, v49
    v_mul_f32 v39, v39, v49
    v_mul_f32 v40, v40, v49
    v_mul_f32 v41, v41, v49
    v_mul_f32 v42, v42, v49
    v_mul_f32 v43, v43, v49
    v_lshlrev_b32 v50, 7, v4
    v_lshl_add_u32 v50, v2, 3, v50
    v_cvt_pk_bf16_f32 v16, v32, v33
    v_cvt_pk_bf16_f32 v17, v34, v35
    v_cmp_gt_u32 vcc, 2, v2
    s_nop 1
    s_and_saveexec_b64 s[80:81], vcc
    ds_write_b64 v50, v[16:17] offset:36864
    s_or_b64 exec, exec, s[80:81]
    s_nop 1
    v_cvt_pk_bf16_f32 v16, v36, v37
    v_cvt_pk_bf16_f32 v17, v38, v39
    ds_write_b64 v50, v[16:17] offset:36880
    s_nop 1
    v_cvt_pk_bf16_f32 v16, v40, v41
    v_cvt_pk_bf16_f32 v17, v42, v43
    ds_write_b64 v50, v[16:17] offset:36912
    s_nop 1
at_skip:
    s_waitcnt lgkmcnt(0)
    s_barrier
    v_lshlrev_b32 v50, 7, v1
    v_lshl_add_u32 v50, v2, 4, v50
    ds_read_b128 v[16:19], v50 offset:36864
    ds_read_b128 v[20:23], v50 offset:36928
    ds_read_b128 v[24:27], v50 offset:38912
    ds_read_b128 v[28:31], v50 offset:38976
    v_lshl_add_u32 v51, v3, 6, v1
    v_mul_u32_u24 v51, 144, v51
    v_lshl_add_u32 v51, v2, 4, v51
    s_lshl_b32 s9, s4, 18
    s_add_u32 s9, s9, s5
    v_lshlrev_b32 v52, 13, v1
    v_lshl_add_u32 v52, v3, 7, v52
    v_lshl_add_u32 v52, v2, 3, v52
    ds_read_b128 v[40:43], v51 offset:0
    ds_read_b128 v[44:47], v51 offset:64
    v_mov_b32 v32, 0
    v_mov_b32 v33, 0
    v_mov_b32 v34, 0
    v_mov_b32 v35, 0
    v_mov_b32 v36, 0
    v_mov_b32 v37, 0
    v_mov_b32 v38, 0
    v_mov_b32 v39, 0
    s_waitcnt lgkmcnt(0)
    v_mfma_f32_16x16x32_bf16 v[32:35], v[40:43], v[16:19], v[32:35]
    v_mfma_f32_16x16x32_bf16 v[32:35], v[44:47], v[20:23], v[32:35]
    v_mfma_f32_16x16x32_bf16 v[36:39], v[40:43], v[24:27], v[36:39]
    v_mfma_f32_16x16x32_bf16 v[36:39], v[44:47], v[28:31], v[36:39]
    s_nop 7
    v_cvt_pk_bf16_f32 v48, v32, v33
    v_cvt_pk_bf16_f32 v49, v34, v35
    v_add_u32 v53, 0, v52
    buffer_store_dwordx2 v[48:49], v53, s[20:23], s9 offen
    s_nop 1
    v_cvt_pk_bf16_f32 v48, v36, v37
    v_cvt_pk_bf16_f32 v49, v38, v39
    v_add_u32 v53, 131072, v52
    buffer_store_dwordx2 v[48:49], v53, s[20:23], s9 offen
    s_nop 1
    ds_read_b128 v[40:43], v51 offset:2304
    ds_read_b128 v[44:47], v51 offset:2368
    v_mov_b32 v32, 0
    v_mov_b32 v33, 0
    v_mov_b32 v34, 0
    v_mov_b32 v35, 0
    v_mov_b32 v36, 0
    v_mov_b32 v37, 0
    v_mov_b32 v38, 0
    v_mov_b32 v39, 0
    s_waitcnt lgkmcnt(0)
    v_mfma_f32_16x16x32_bf16 v[32:35], v[40:43], v[16:19], v[32:35]
    v_mfma_f32_16x16x32_bf16 v[32:35], v[44:47], v[20:23], v[32:35]
    v_mfma_f32_16x16x32_bf16 v[36:39], v[40:43], v[24:27], v[36:39]
    v_mfma_f32_16x16x32_bf16 v[36:39], v[44:47], v[28:31], v[36:39]
    s_nop 7
    v_cvt_pk_bf16_f32 v48, v32, v33
    v_cvt_pk_bf16_f32 v49, v34, v35
    v_add_u32 v53, 32, v52
    buffer_store_dwordx2 v[48:49], v53, s[20:23], s9 offen
    s_nop 1
    v_cvt_pk_bf16_f32 v48, v36, v37
    v_cvt_pk_bf16_f32 v49, v38, v39
    v_add_u32 v53, 131104, v52
    buffer_store_dwordx2 v[48:49], v53, s[20:23], s9 offen
    s_nop 1
    ds_read_b128 v[40:43], v51 offset:4608
    ds_read_b128 v[44:47], v51 offset:4672
    v_mov_b32 v32, 0
    v_mov_b32 v33, 0
    v_mov_b32 v34, 0
    v_mov_b32 v35, 0
    v_mov_b32 v36, 0
    v_mov_b32 v37, 0
    v_mov_b32 v38, 0
    v_mov_b32 v39, 0
    s_waitcnt lgkmcnt(0)
    v_mfma_f32_16x16x32_bf16 v[32:35], v[40:43], v[16:19], v[32:35]
    v_mfma_f32_16x16x32_bf16 v[32:35], v[44:47], v[20:23], v[32:35]
    v_mfma_f32_16x16x32_bf16 v[36:39], v[40:43], v[24:27], v[36:39]
    v_mfma_f32_16x16x32_bf16 v[36:39], v[44:47], v[28:31], v[36:39]
    s_nop 7
    v_cvt_pk_bf16_f32 v48, v32, v33
    v_cvt_pk_bf16_f32 v49, v34, v35
    v_add_u32 v53, 64, v52
    buffer_store_dwordx2 v[48:49], v53, s[20:23], s9 offen
    s_nop 1
    v_cvt_pk_bf16_f32 v48, v36, v37
    v_cvt_pk_bf16_f32 v49, v38, v39
    v_add_u32 v53, 131136, v52
    buffer_store_dwordx2 v[48:49], v53, s[20:23], s9 offen
    s_nop 1
    ds_read_b128 v[40:43], v51 offset:6912
    ds_read_b128 v[44:47], v51 offset:6976
    v_mov_b32 v32, 0
    v_mov_b32 v33, 0
    v_mov_b32 v34, 0
    v_mov_b32 v35, 0
    v_mov_b32 v36, 0
    v_mov_b32 v37, 0
    v_mov_b32 v38, 0
    v_mov_b32 v39, 0
    s_waitcnt lgkmcnt(0)
    v_mfma_f32_16x16x32_bf16 v[32:35], v[40:43], v[16:19], v[32:35]
    v_mfma_f32_16x16x32_bf16 v[32:35], v[44:47], v[20:23], v[32:35]
    v_mfma_f32_16x16x32_bf16 v[36:39], v[40:43], v[24:27], v[36:39]
    v_mfma_f32_16x16x32_bf16 v[36:39], v[44:47], v[28:31], v[36:39]
    s_nop 7
    v_cvt_pk_bf16_f32 v48, v32, v33
    v_cvt_pk_bf16_f32 v49, v34, v35
    v_add_u32 v53, 96, v52
    buffer_store_dwordx2 v[48:49], v53, s[20:23], s9 offen
    s_nop 1
    v_cvt_pk_bf16_f32 v48, v36, v37
    v_cvt_pk_bf16_f32 v49, v38, v39
    v_add_u32 v53, 131168, v52
    buffer_store_dwordx2 v[48:49], v53, s[20:23], s9 offen
    s_nop 1
at_end:
    s_endpgm
.globl go1_kernel
.p2align 8
.type go1_kernel,@function
go1_kernel:
    s_load_dwordx16 s[36:51], s[0:1], 0
    s_load_dwordx8 s[52:59], s[0:1], 64
    s_load_dwordx2 s[60:61], s[0:1], 104
    s_load_dwordx2 s[62:63], s[0:1], 120
    s_waitcnt lgkmcnt(0)
    s_cmp_ge_u32 s2, 112
    s_cbranch_scc1 go1_end
    s_add_u32 s12, s62, 100663296
    s_addc_u32 s13, s63, 0
    s_mov_b32 s14, 16777216
    s_mov_b32 s15, 0x20000
    s_add_u32 s16, s62, 29360128
    s_addc_u32 s17, s63, 0
    s_mov_b32 s18, 3670016
    s_mov_b32 s19, 0x20000
    s_add_u32 s20, s62, 8388608
    s_addc_u32 s21, s63, 0
    s_mov_b32 s22, 1835008
    s_mov_b32 s23, 0x20000
    s_add_u32 s24, s62, 4194304
    s_addc_u32 s25, s63, 0
    s_mov_b32 s26, 1835008
    s_mov_b32 s27, 0x20000
    s_and_b32 s4, s2, 15
    s_lshr_b32 s5, s2, 4
    v_and_b32 v1, 31, v0
    v_bfe_u32 v2, v0, 5, 1
    v_bfe_u32 v3, v0, 6, 1
    v_lshrrev_b32 v4, 7, v0
    s_lshl_b32 s6, s4, 7
    v_lshl_add_u32 v5, v4, 6, v1
    v_add_u32 v5, s6, v5
    s_lshl_b32 s7, s5, 6
    v_lshl_add_u32 v6, v3, 5, v1
    v_add_u32 v6, s7, v6
    s_mov_b32 s8, 8192
    v_mul_lo_u32 v7, v5, s8
    v_lshl_add_u32 v7, v2, 4, v7
    v_add_u32 v8, 262144, v7
    v_mul_lo_u32 v9, v6, s8
    v_lshl_add_u32 v9, v2, 4, v9
    v_mov_b32 v16, 0
    v_mov_b32 v17, 0
    v_mov_b32 v18, 0
    v_mov_b32 v19, 0
    v_mov_b32 v20, 0
    v_mov_b32 v21, 0
    v_mov_b32 v22, 0
    v_mov_b32 v23, 0
    v_mov_b32 v24, 0
    v_mov_b32 v25, 0
    v_mov_b32 v26, 0
    v_mov_b32 v27, 0
    v_mov_b32 v28, 0
    v_mov_b32 v29, 0
    v_mov_b32 v30, 0
    v_mov_b32 v31, 0
    v_mov_b32 v32, 0
    v_mov_b32 v33, 0
    v_mov_b32 v34, 0
    v_mov_b32 v35, 0
    v_mov_b32 v36, 0
    v_mov_b32 v37, 0
    v_mov_b32 v38, 0
    v_mov_b32 v39, 0
    v_mov_b32 v40, 0
    v_mov_b32 v41, 0
    v_mov_b32 v42, 0
    v_mov_b32 v43, 0
    v_mov_b32 v44, 0
    v_mov_b32 v45, 0
    v_mov_b32 v46, 0
    v_mov_b32 v47, 0
    s_mov_b32 s9, 0
go1_loop:
    buffer_load_dwordx4 v[48:51], v9, s[16:19], s9 offen offset:0
    buffer_load_dwordx4 v[52:55], v7, s[12:15], s9 offen offset:0
    buffer_load_dwordx4 v[56:59], v8, s[12:15], s9 offen offset:0
    buffer_load_dwordx4 v[60:63], v9, s[16:19], s9 offen offset:32
    buffer_load_dwordx4 v[64:67], v7, s[12:15], s9 offen offset:32
    buffer_load_dwordx4 v[68:71], v8, s[12:15], s9 offen offset:32
    buffer_load_dwordx4 v[72:75], v9, s[16:19], s9 offen offset:64
    buffer_load_dwordx4 v[76:79], v7, s[12:15], s9 offen offset:64
    buffer_load_dwordx4 v[80:83], v8, s[12:15], s9 offen offset:64
    buffer_load_dwordx4 v[84:87], v9, s[16:19], s9 offen offset:96
    buffer_load_dwordx4 v[88:91], v7, s[12:15], s9 offen offset:96
    buffer_load_dwordx4 v[92:95], v8, s[12:15], s9 offen offset:96
    s_waitcnt vmcnt(9)
    v_mfma_f32_32x32x16_bf16 v[16:31], v[48:51], v[52:55], v[16:31]
    v_mfma_f32_32x32x16_bf16 v[32:47], v[48:51], v[56:59], v[32:47]
    s_waitcnt vmcnt(6)
    v_mfma_f32_32x32x16_bf16 v[16:31], v[60:63], v[64:67], v[16:31]
    v_mfma_f32_32x32x16_bf16 v[32:47], v[60:63], v[68:71], v[32:47]
    s_waitcnt vmcnt(3)
    v_mfma_f32_32x32x16_bf16 v[16:31], v[72:75], v[76:79], v[16:31]
    v_mfma_f32_32x32x16_bf16 v[32:47], v[72:75], v[80:83], v[32:47]
    s_waitcnt vmcnt(0)
    v_mfma_f32_32x32x16_bf16 v[16:31], v[84:87], v[88:91], v[16:31]
    v_mfma_f32_32x32x16_bf16 v[32:47], v[84:87], v[92:95], v[32:47]
    s_add_u32 s9, s9, 128
    s_cmp_lt_u32 s9, 8192
    s_cbranch_scc1 go1_loop
    s_nop 15
    s_mov_b32 s8, 896
    v_mul_lo_u32 v7, v5, s8
    v_lshl_add_u32 v10, v3, 5, 0
    v_add_u32 v10, s7, v10
    v_lshl_add_u32 v10, v2, 2, v10
    v_lshl_add_u32 v7, v10, 1, v7
    v_add_u32 v8, 0, v7
    buffer_load_dwordx2 v[10:11], v8, s[24:27], 0 offen
    v_cvt_pk_bf16_f32 v16, v16, v16
    v_lshlrev_b32 v16, 16, v16
    v_cvt_pk_bf16_f32 v17, v17, v17
    v_lshlrev_b32 v17, 16, v17
    v_cvt_pk_bf16_f32 v18, v18, v18
    v_lshlrev_b32 v18, 16, v18
    v_cvt_pk_bf16_f32 v19, v19, v19
    v_lshlrev_b32 v19, 16, v19
    s_waitcnt vmcnt(0)
    v_lshlrev_b32 v12, 16, v10
    v_and_b32 v13, 0xffff0000, v10
    v_lshlrev_b32 v14, 16, v11
    v_and_b32 v15, 0xffff0000, v11
    v_add_f32 v16, v16, v12
    v_add_f32 v17, v17, v13
    v_add_f32 v18, v18, v14
    v_add_f32 v19, v19, v15
    v_cvt_pk_bf16_f32 v10, v16, v17
    v_cvt_pk_bf16_f32 v11, v18, v19
    buffer_store_dwordx2 v[10:11], v8, s[20:23], 0 offen
    s_nop 1
    v_add_u32 v8, 16, v7
    buffer_load_dwordx2 v[10:11], v8, s[24:27], 0 offen
    v_cvt_pk_bf16_f32 v20, v20, v20
    v_lshlrev_b32 v20, 16, v20
    v_cvt_pk_bf16_f32 v21, v21, v21
    v_lshlrev_b32 v21, 16, v21
    v_cvt_pk_bf16_f32 v22, v22, v22
    v_lshlrev_b32 v22, 16, v22
    v_cvt_pk_bf16_f32 v23, v23, v23
    v_lshlrev_b32 v23, 16, v23
    s_waitcnt vmcnt(0)
    v_lshlrev_b32 v12, 16, v10
    v_and_b32 v13, 0xffff0000, v10
    v_lshlrev_b32 v14, 16, v11
    v_and_b32 v15, 0xffff0000, v11
    v_add_f32 v20, v20, v12
    v_add_f32 v21, v21, v13
    v_add_f32 v22, v22, v14
    v_add_f32 v23, v23, v15
    v_cvt_pk_bf16_f32 v10, v20, v21
    v_cvt_pk_bf16_f32 v11, v22, v23
    buffer_store_dwordx2 v[10:11], v8, s[20:23], 0 offen
    s_nop 1
    v_add_u32 v8, 32, v7
    buffer_load_dwordx2 v[10:11], v8, s[24:27], 0 offen
    v_cvt_pk_bf16_f32 v24, v24, v24
    v_lshlrev_b32 v24, 16, v24
    v_cvt_pk_bf16_f32 v25, v25, v25
    v_lshlrev_b32 v25, 16, v25
    v_cvt_pk_bf16_f32 v26, v26, v26
    v_lshlrev_b32 v26, 16, v26
    v_cvt_pk_bf16_f32 v27, v27, v27
    v_lshlrev_b32 v27, 16, v27
    s_waitcnt vmcnt(0)
    v_lshlrev_b32 v12, 16, v10
    v_and_b32 v13, 0xffff0000, v10
    v_lshlrev_b32 v14, 16, v11
    v_and_b32 v15, 0xffff0000, v11
    v_add_f32 v24, v24, v12
    v_add_f32 v25, v25, v13
    v_add_f32 v26, v26, v14
    v_add_f32 v27, v27, v15
    v_cvt_pk_bf16_f32 v10, v24, v25
    v_cvt_pk_bf16_f32 v11, v26, v27
    buffer_store_dwordx2 v[10:11], v8, s[20:23], 0 offen
    s_nop 1
    v_add_u32 v8, 48, v7
    buffer_load_dwordx2 v[10:11], v8, s[24:27], 0 offen
    v_cvt_pk_bf16_f32 v28, v28, v28
    v_lshlrev_b32 v28, 16, v28
    v_cvt_pk_bf16_f32 v29, v29, v29
    v_lshlrev_b32 v29, 16, v29
    v_cvt_pk_bf16_f32 v30, v30, v30
    v_lshlrev_b32 v30, 16, v30
    v_cvt_pk_bf16_f32 v31, v31, v31
    v_lshlrev_b32 v31, 16, v31
    s_waitcnt vmcnt(0)
    v_lshlrev_b32 v12, 16, v10
    v_and_b32 v13, 0xffff0000, v10
    v_lshlrev_b32 v14, 16, v11
    v_and_b32 v15, 0xffff0000, v11
    v_add_f32 v28, v28, v12
    v_add_f32 v29, v29, v13
    v_add_f32 v30, v30, v14
    v_add_f32 v31, v31, v15
    v_cvt_pk_bf16_f32 v10, v28, v29
    v_cvt_pk_bf16_f32 v11, v30, v31
    buffer_store_dwordx2 v[10:11], v8, s[20:23], 0 offen
    s_nop 1
    v_add_u32 v8, 28672, v7
    buffer_load_dwordx2 v[10:11], v8, s[24:27], 0 offen
    v_cvt_pk_bf16_f32 v32, v32, v32
    v_lshlrev_b32 v32, 16, v32
    v_cvt_pk_bf16_f32 v33, v33, v33
    v_lshlrev_b32 v33, 16, v33
    v_cvt_pk_bf16_f32 v34, v34, v34
    v_lshlrev_b32 v34, 16, v34
    v_cvt_pk_bf16_f32 v35, v35, v35
    v_lshlrev_b32 v35, 16, v35
    s_waitcnt vmcnt(0)
    v_lshlrev_b32 v12, 16, v10
    v_and_b32 v13, 0xffff0000, v10
    v_lshlrev_b32 v14, 16, v11
    v_and_b32 v15, 0xffff0000, v11
    v_add_f32 v32, v32, v12
    v_add_f32 v33, v33, v13
    v_add_f32 v34, v34, v14
    v_add_f32 v35, v35, v15
    v_cvt_pk_bf16_f32 v10, v32, v33
    v_cvt_pk_bf16_f32 v11, v34, v35
    buffer_store_dwordx2 v[10:11], v8, s[20:23], 0 offen
    s_nop 1
    v_add_u32 v8, 28688, v7
    buffer_load_dwordx2 v[10:11], v8, s[24:27], 0 offen
    v_cvt_pk_bf16_f32 v36, v36, v36
    v_lshlrev_b32 v36, 16, v36
    v_cvt_pk_bf16_f32 v37, v37, v37
    v_lshlrev_b32 v37, 16, v37
    v_cvt_pk_bf16_f32 v38, v38, v38
    v_lshlrev_b32 v38, 16, v38
    v_cvt_pk_bf16_f32 v39, v39, v39
    v_lshlrev_b32 v39, 16, v39
    s_waitcnt vmcnt(0)
    v_lshlrev_b32 v12, 16, v10
    v_and_b32 v13, 0xffff0000, v10
    v_lshlrev_b32 v14, 16, v11
    v_and_b32 v15, 0xffff0000, v11
    v_add_f32 v36, v36, v12
    v_add_f32 v37, v37, v13
    v_add_f32 v38, v38, v14
    v_add_f32 v39, v39, v15
    v_cvt_pk_bf16_f32 v10, v36, v37
    v_cvt_pk_bf16_f32 v11, v38, v39
    buffer_store_dwordx2 v[10:11], v8, s[20:23], 0 offen
    s_nop 1
    v_add_u32 v8, 28704, v7
    buffer_load_dwordx2 v[10:11], v8, s[24:27], 0 offen
    v_cvt_pk_bf16_f32 v40, v40, v40
    v_lshlrev_b32 v40, 16, v40
    v_cvt_pk_bf16_f32 v41, v41, v41
    v_lshlrev_b32 v41, 16, v41
    v_cvt_pk_bf16_f32 v42, v42, v42
    v_lshlrev_b32 v42, 16, v42
    v_cvt_pk_bf16_f32 v43, v43, v43
    v_lshlrev_b32 v43, 16, v43
    s_waitcnt vmcnt(0)
    v_lshlrev_b32 v12, 16, v10
    v_and_b32 v13, 0xffff0000, v10
    v_lshlrev_b32 v14, 16, v11
    v_and_b32 v15, 0xffff0000, v11
    v_add_f32 v40, v40, v12
    v_add_f32 v41, v41, v13
    v_add_f32 v42, v42, v14
    v_add_f32 v43, v43, v15
    v_cvt_pk_bf16_f32 v10, v40, v41
    v_cvt_pk_bf16_f32 v11, v42, v43
    buffer_store_dwordx2 v[10:11], v8, s[20:23], 0 offen
    s_nop 1
    v_add_u32 v8, 28720, v7
    buffer_load_dwordx2 v[10:11], v8, s[24:27], 0 offen
    v_cvt_pk_bf16_f32 v44, v44, v44
    v_lshlrev_b32 v44, 16, v44
    v_cvt_pk_bf16_f32 v45, v45, v45
    v_lshlrev_b32 v45, 16, v45
    v_cvt_pk_bf16_f32 v46, v46, v46
    v_lshlrev_b32 v46, 16, v46
    v_cvt_pk_bf16_f32 v47, v47, v47
    v_lshlrev_b32 v47, 16, v47
    s_waitcnt vmcnt(0)
    v_lshlrev_b32 v12, 16, v10
    v_and_b32 v13, 0xffff0000, v10
    v_lshlrev_b32 v14, 16, v11
    v_and_b32 v15, 0xffff0000, v11
    v_add_f32 v44, v44, v12
    v_add_f32 v45, v45, v13
    v_add_f32 v46, v46, v14
    v_add_f32 v47, v47, v15
    v_cvt_pk_bf16_f32 v10, v44, v45
    v_cvt_pk_bf16_f32 v11, v46, v47
    buffer_store_dwordx2 v[10:11], v8, s[20:23], 0 offen
    s_nop 1
go1_end:
    s_endpgm
.globl row1_kernel
.p2align 8
.type row1_kernel,@function
row1_kernel:
    s_load_dwordx16 s[36:51], s[0:1], 0
    s_load_dwordx8 s[52:59], s[0:1], 64
    s_load_dwordx2 s[60:61], s[0:1], 104
    s_load_dwordx2 s[62:63], s[0:1], 120
    s_waitcnt lgkmcnt(0)
    s_cmp_ge_u32 s2, 64
    s_cbranch_scc1 row1_end
    s_add_u32 s12, s62, 8388608
    s_addc_u32 s13, s63, 0
    s_mov_b32 s14, 1835008
    s_mov_b32 s15, 0x20000
    s_add_u32 s16, s62, 2097152
    s_addc_u32 s17, s63, 0
    s_mov_b32 s18, 1835008
    s_mov_b32 s19, 0x20000
    s_add_u32 s20, s62, 4194304
    s_addc_u32 s21, s63, 0
    s_mov_b32 s22, 1835008
    s_mov_b32 s23, 0x20000
    s_add_u32 s24, s62, 6291456
    s_addc_u32 s25, s63, 0
    s_mov_b32 s26, 1835008
    s_mov_b32 s27, 0x20000
    v_lshrrev_b32 v1, 2, v0
    v_and_b32 v2, 3, v0
    s_lshl_b32 s4, s2, 6
    v_lshlrev_b32 v3, 12, v1
    v_lshl_add_u32 v3, v2, 4, v3
    v_add_u32 v3, s4, v3
    buffer_load_dwordx4 v[8:11], v3, s[16:19], 0 offen offset:0
    v_add_u32 v3, 0x40000, v3
    buffer_load_dwordx4 v[12:15], v3, s[16:19], 0 offen offset:0
    v_add_u32 v3, 0x40000, v3
    buffer_load_dwordx4 v[16:19], v3, s[16:19], 0 offen offset:0
    v_add_u32 v3, 0x40000, v3
    buffer_load_dwordx4 v[20:23], v3, s[16:19], 0 offen offset:0
    v_add_u32 v3, 0x40000, v3
    buffer_load_dwordx4 v[24:27], v3, s[16:19], 0 offen offset:0
    v_add_u32 v3, 0x40000, v3
    buffer_load_dwordx4 v[28:31], v3, s[16:19], 0 offen offset:0
    v_add_u32 v3, 0x40000, v3
    buffer_load_dwordx4 v[32:35], v3, s[16:19], 0 offen offset:0
    v_add_u32 v3, 0x40000, v3
    v_mul_u32_u24 v4, 7296, v2
    v_lshl_add_u32 v4, v1, 1, v4
    s_waitcnt vmcnt(0)
    ds_write_b16 v4, v8 offset:0
    ds_write_b16_d16_hi v4, v8 offset:912
    ds_write_b16 v4, v9 offset:1824
    ds_write_b16_d16_hi v4, v9 offset:2736
    ds_write_b16 v4, v10 offset:3648
    ds_write_b16_d16_hi v4, v10 offset:4560
    ds_write_b16 v4, v11 offset:5472
    ds_write_b16_d16_hi v4, v11 offset:6384
    ds_write_b16 v4, v12 offset:128
    ds_write_b16_d16_hi v4, v12 offset:1040
    ds_write_b16 v4, v13 offset:1952
    ds_write_b16_d16_hi v4, v13 offset:2864
    ds_write_b16 v4, v14 offset:3776
    ds_write_b16_d16_hi v4, v14 offset:4688
    ds_write_b16 v4, v15 offset:5600
    ds_write_b16_d16_hi v4, v15 offset:6512
    ds_write_b16 v4, v16 offset:256
    ds_write_b16_d16_hi v4, v16 offset:1168
    ds_write_b16 v4, v17 offset:2080
    ds_write_b16_d16_hi v4, v17 offset:2992
    ds_write_b16 v4, v18 offset:3904
    ds_write_b16_d16_hi v4, v18 offset:4816
    ds_write_b16 v4, v19 offset:5728
    ds_write_b16_d16_hi v4, v19 offset:6640
    ds_write_b16 v4, v20 offset:384
    ds_write_b16_d16_hi v4, v20 offset:1296
    ds_write_b16 v4, v21 offset:2208
    ds_write_b16_d16_hi v4, v21 offset:3120
    ds_write_b16 v4, v22 offset:4032
    ds_write_b16_d16_hi v4, v22 offset:4944
    ds_write_b16 v4, v23 offset:5856
    ds_write_b16_d16_hi v4, v23 offset:6768
    ds_write_b16 v4, v24 offset:512
    ds_write_b16_d16_hi v4, v24 offset:1424
    ds_write_b16 v4, v25 offset:2336
    ds_write_b16_d16_hi v4, v25 offset:3248
    ds_write_b16 v4, v26 offset:4160
    ds_write_b16_d16_hi v4, v26 offset:5072
    ds_write_b16 v4, v27 offset:5984
    ds_write_b16_d16_hi v4, v27 offset:6896
    ds_write_b16 v4, v28 offset:640
    ds_write_b16_d16_hi v4, v28 offset:1552
    ds_write_b16 v4, v29 offset:2464
    ds_write_b16_d16_hi v4, v29 offset:3376
    ds_write_b16 v4, v30 offset:4288
    ds_write_b16_d16_hi v4, v30 offset:5200
    ds_write_b16 v4, v31 offset:6112
    ds_write_b16_d16_hi v4, v31 offset:7024
    ds_write_b16 v4, v32 offset:768
    ds_write_b16_d16_hi v4, v32 offset:1680
    ds_write_b16 v4, v33 offset:2592
    ds_write_b16_d16_hi v4, v33 offset:3504
    ds_write_b16 v4, v34 offset:4416
    ds_write_b16_d16_hi v4, v34 offset:5328
    ds_write_b16 v4, v35 offset:6240
    ds_write_b16_d16_hi v4, v35 offset:7152
    v_and_b32 v5, 63, v0
    v_lshrrev_b32 v6, 6, v0
    v_xor_b32 v100, 1, v5
    v_lshlrev_b32 v100, 2, v100
    v_xor_b32 v101, 2, v5
    v_lshlrev_b32 v101, 2, v101
    v_xor_b32 v102, 4, v5
    v_lshlrev_b32 v102, 2, v102
    v_xor_b32 v103, 8, v5
    v_lshlrev_b32 v103, 2, v103
    v_xor_b32 v104, 16, v5
    v_lshlrev_b32 v104, 2, v104
    v_xor_b32 v105, 32, v5
    v_lshlrev_b32 v105, 2, v105
    v_cmp_gt_u32 vcc, 56, v5
    v_mov_b32 v98, 0
    s_nop 1
    v_cndmask_b32 v98, v98, 1.0, vcc
    v_mul_u32_u24 v7, 7296, v6
    v_lshl_add_u32 v7, v5, 4, v7
    v_mul_u32_u24 v40, 7168, v6
    v_lshl_add_u32 v40, v5, 4, v40
    s_mul_i32 s5, s2, 28672
    v_add_u32 v40, s5, v40
    s_waitcnt lgkmcnt(0)
    s_barrier
    s_and_saveexec_b64 s[30:31], vcc
    s_mov_b32 s6, 0
row1_loop:
    buffer_load_dwordx4 v[8:11], v40, s[12:15], 0 offen
    ds_read_b128 v[12:15], v7
    s_waitcnt vmcnt(0) lgkmcnt(0)
    s_or_b64 exec, exec, s[30:31]
    v_lshlrev_b32 v16, 16, v8
    v_and_b32 v17, 0xffff0000, v8
    v_lshlrev_b32 v32, 16, v12
    v_and_b32 v33, 0xffff0000, v12
    v_lshlrev_b32 v18, 16, v9
    v_and_b32 v19, 0xffff0000, v9
    v_lshlrev_b32 v34, 16, v13
    v_and_b32 v35, 0xffff0000, v13
    v_lshlrev_b32 v20, 16, v10
    v_and_b32 v21, 0xffff0000, v10
    v_lshlrev_b32 v36, 16, v14
    v_and_b32 v37, 0xffff0000, v14
    v_lshlrev_b32 v22, 16, v11
    v_and_b32 v23, 0xffff0000, v11
    v_lshlrev_b32 v38, 16, v15
    v_and_b32 v39, 0xffff0000, v15
    v_cndmask_b32 v16, 0, v16, vcc
    v_cndmask_b32 v32, 0, v32, vcc
    v_cndmask_b32 v17, 0, v17, vcc
    v_cndmask_b32 v33, 0, v33, vcc
    v_cndmask_b32 v18, 0, v18, vcc
    v_cndmask_b32 v34, 0, v34, vcc
    v_cndmask_b32 v19, 0, v19, vcc
    v_cndmask_b32 v35, 0, v35, vcc
    v_cndmask_b32 v20, 0, v20, vcc
    v_cndmask_b32 v36, 0, v36, vcc
    v_cndmask_b32 v21, 0, v21, vcc
    v_cndmask_b32 v37, 0, v37, vcc
    v_cndmask_b32 v22, 0, v22, vcc
    v_cndmask_b32 v38, 0, v38, vcc
    v_cndmask_b32 v23, 0, v23, vcc
    v_cndmask_b32 v39, 0, v39, vcc
    v_add_f32 v96, v16, v17
    v_add_f32 v96, v96, v18
    v_add_f32 v96, v96, v19
    v_add_f32 v96, v96, v20
    v_add_f32 v96, v96, v21
    v_add_f32 v96, v96, v22
    v_add_f32 v96, v96, v23
    v_mul_f32 v96, v96, v98
    ds_bpermute_b32 v99, v100, v96
    s_waitcnt lgkmcnt(0)
    v_add_f32 v96, v96, v99
    ds_bpermute_b32 v99, v101, v96
    s_waitcnt lgkmcnt(0)
    v_add_f32 v96, v96, v99
    ds_bpermute_b32 v99, v102, v96
    s_waitcnt lgkmcnt(0)
    v_add_f32 v96, v96, v99
    ds_bpermute_b32 v99, v103, v96
    s_waitcnt lgkmcnt(0)
    v_add_f32 v96, v96, v99
    ds_bpermute_b32 v99, v104, v96
    s_waitcnt lgkmcnt(0)
    v_add_f32 v96, v96, v99
    ds_bpermute_b32 v99, v105, v96
    s_waitcnt lgkmcnt(0)
    v_add_f32 v96, v96, v99
    v_mul_f32 v96, 0x3b124925, v96
    v_sub_f32 v24, v16, v96
    v_sub_f32 v25, v17, v96
    v_sub_f32 v26, v18, v96
    v_sub_f32 v27, v19, v96
    v_sub_f32 v28, v20, v96
    v_sub_f32 v29, v21, v96
    v_sub_f32 v30, v22, v96
    v_sub_f32 v31, v23, v96
    v_mul_f32 v97, v24, v24
    v_fma_f32 v97, v25, v25, v97
    v_fma_f32 v97, v26, v26, v97
    v_fma_f32 v97, v27, v27, v97
    v_fma_f32 v97, v28, v28, v97
    v_fma_f32 v97, v29, v29, v97
    v_fma_f32 v97, v30, v30, v97
    v_fma_f32 v97, v31, v31, v97
    v_mul_f32 v97, v97, v98
    ds_bpermute_b32 v99, v100, v97
    s_waitcnt lgkmcnt(0)
    v_add_f32 v97, v97, v99
    ds_bpermute_b32 v99, v101, v97
    s_waitcnt lgkmcnt(0)
    v_add_f32 v97, v97, v99
    ds_bpermute_b32 v99, v102, v97
    s_waitcnt lgkmcnt(0)
    v_add_f32 v97, v97, v99
    ds_bpermute_b32 v99, v103, v97
    s_waitcnt lgkmcnt(0)
    v_add_f32 v97, v97, v99
    ds_bpermute_b32 v99, v104, v97
    s_waitcnt lgkmcnt(0)
    v_add_f32 v97, v97, v99
    ds_bpermute_b32 v99, v105, v97
    s_waitcnt lgkmcnt(0)
    v_add_f32 v97, v97, v99
    v_mul_f32 v97, 0x3b124925, v97
    v_add_f32 v97, 0x3727c5ac, v97
    v_rsq_f32 v97, v97
    s_nop 1
    v_mul_f32 v24, v24, v97
    v_mul_f32 v25, v25, v97
    v_mul_f32 v26, v26, v97
    v_mul_f32 v27, v27, v97
    v_mul_f32 v28, v28, v97
    v_mul_f32 v29, v29, v97
    v_mul_f32 v30, v30, v97
    v_mul_f32 v31, v31, v97
    v_cvt_pk_bf16_f32 v24, v24, v24
    v_lshlrev_b32 v24, 16, v24
    v_mul_f32 v24, v24, v32
    v_cvt_pk_bf16_f32 v24, v24, v24
    v_lshlrev_b32 v24, 16, v24
    v_add_f32 v16, v16, v24
    v_cvt_pk_bf16_f32 v16, v16, v16
    v_lshlrev_b32 v16, 16, v16
    v_cvt_pk_bf16_f32 v25, v25, v25
    v_lshlrev_b32 v25, 16, v25
    v_mul_f32 v25, v25, v33
    v_cvt_pk_bf16_f32 v25, v25, v25
    v_lshlrev_b32 v25, 16, v25
    v_add_f32 v17, v17, v25
    v_cvt_pk_bf16_f32 v17, v17, v17
    v_lshlrev_b32 v17, 16, v17
    v_cvt_pk_bf16_f32 v26, v26, v26
    v_lshlrev_b32 v26, 16, v26
    v_mul_f32 v26, v26, v34
    v_cvt_pk_bf16_f32 v26, v26, v26
    v_lshlrev_b32 v26, 16, v26
    v_add_f32 v18, v18, v26
    v_cvt_pk_bf16_f32 v18, v18, v18
    v_lshlrev_b32 v18, 16, v18
    v_cvt_pk_bf16_f32 v27, v27, v27
    v_lshlrev_b32 v27, 16, v27
    v_mul_f32 v27, v27, v35
    v_cvt_pk_bf16_f32 v27, v27, v27
    v_lshlrev_b32 v27, 16, v27
    v_add_f32 v19, v19, v27
    v_cvt_pk_bf16_f32 v19, v19, v19
    v_lshlrev_b32 v19, 16, v19
    v_cvt_pk_bf16_f32 v28, v28, v28
    v_lshlrev_b32 v28, 16, v28
    v_mul_f32 v28, v28, v36
    v_cvt_pk_bf16_f32 v28, v28, v28
    v_lshlrev_b32 v28, 16, v28
    v_add_f32 v20, v20, v28
    v_cvt_pk_bf16_f32 v20, v20, v20
    v_lshlrev_b32 v20, 16, v20
    v_cvt_pk_bf16_f32 v29, v29, v29
    v_lshlrev_b32 v29, 16, v29
    v_mul_f32 v29, v29, v37
    v_cvt_pk_bf16_f32 v29, v29, v29
    v_lshlrev_b32 v29, 16, v29
    v_add_f32 v21, v21, v29
    v_cvt_pk_bf16_f32 v21, v21, v21
    v_lshlrev_b32 v21, 16, v21
    v_cvt_pk_bf16_f32 v30, v30, v30
    v_lshlrev_b32 v30, 16, v30
    v_mul_f32 v30, v30, v38
    v_cvt_pk_bf16_f32 v30, v30, v30
    v_lshlrev_b32 v30, 16, v30
    v_add_f32 v22, v22, v30
    v_cvt_pk_bf16_f32 v22, v22, v22
    v_lshlrev_b32 v22, 16, v22
    v_cvt_pk_bf16_f32 v31, v31, v31
    v_lshlrev_b32 v31, 16, v31
    v_mul_f32 v31, v31, v39
    v_cvt_pk_bf16_f32 v31, v31, v31
    v_lshlrev_b32 v31, 16, v31
    v_add_f32 v23, v23, v31
    v_cvt_pk_bf16_f32 v23, v23, v23
    v_lshlrev_b32 v23, 16, v23
    v_add_f32 v96, v16, v17
    v_add_f32 v96, v96, v18
    v_add_f32 v96, v96, v19
    v_add_f32 v96, v96, v20
    v_add_f32 v96, v96, v21
    v_add_f32 v96, v96, v22
    v_add_f32 v96, v96, v23
    v_mul_f32 v96, v96, v98
    ds_bpermute_b32 v99, v100, v96
    s_waitcnt lgkmcnt(0)
    v_add_f32 v96, v96, v99
    ds_bpermute_b32 v99, v101, v96
    s_waitcnt lgkmcnt(0)
    v_add_f32 v96, v96, v99
    ds_bpermute_b32 v99, v102, v96
    s_waitcnt lgkmcnt(0)
    v_add_f32 v96, v96, v99
    ds_bpermute_b32 v99, v103, v96
    s_waitcnt lgkmcnt(0)
    v_add_f32 v96, v96, v99
    ds_bpermute_b32 v99, v104, v96
    s_waitcnt lgkmcnt(0)
    v_add_f32 v96, v96, v99
    ds_bpermute_b32 v99, v105, v96
    s_waitcnt lgkmcnt(0)
    v_add_f32 v96, v96, v99
    v_mul_f32 v96, 0x3b124925, v96
    v_sub_f32 v24, v16, v96
    v_sub_f32 v25, v17, v96
    v_sub_f32 v26, v18, v96
    v_sub_f32 v27, v19, v96
    v_sub_f32 v28, v20, v96
    v_sub_f32 v29, v21, v96
    v_sub_f32 v30, v22, v96
    v_sub_f32 v31, v23, v96
    v_mul_f32 v97, v24, v24
    v_fma_f32 v97, v25, v25, v97
    v_fma_f32 v97, v26, v26, v97
    v_fma_f32 v97, v27, v27, v97
    v_fma_f32 v97, v28, v28, v97
    v_fma_f32 v97, v29, v29, v97
    v_fma_f32 v97, v30, v30, v97
    v_fma_f32 v97, v31, v31, v97
    v_mul_f32 v97, v97, v98
    ds_bpermute_b32 v99, v100, v97
    s_waitcnt lgkmcnt(0)
    v_add_f32 v97, v97, v99
    ds_bpermute_b32 v99, v101, v97
    s_waitcnt lgkmcnt(0)
    v_add_f32 v97, v97, v99
    ds_bpermute_b32 v99, v102, v97
    s_waitcnt lgkmcnt(0)
    v_add_f32 v97, v97, v99
    ds_bpermute_b32 v99, v103, v97
    s_waitcnt lgkmcnt(0)
    v_add_f32 v97, v97, v99
    ds_bpermute_b32 v99, v104, v97
    s_waitcnt lgkmcnt(0)
    v_add_f32 v97, v97, v99
    ds_bpermute_b32 v99, v105, v97
    s_waitcnt lgkmcnt(0)
    v_add_f32 v97, v97, v99
    v_mul_f32 v97, 0x3b124925, v97
    v_add_f32 v97, 0x3727c5ac, v97
    v_rsq_f32 v97, v97
    s_nop 1
    v_mul_f32 v24, v24, v97
    v_mul_f32 v25, v25, v97
    v_mul_f32 v26, v26, v97
    v_mul_f32 v27, v27, v97
    v_mul_f32 v28, v28, v97
    v_mul_f32 v29, v29, v97
    v_mul_f32 v30, v30, v97
    v_mul_f32 v31, v31, v97
    v_cvt_pk_bf16_f32 v8, v16, v17
    v_cvt_pk_bf16_f32 v12, v24, v25
    v_cvt_pk_bf16_f32 v9, v18, v19
    v_cvt_pk_bf16_f32 v13, v26, v27
    v_cvt_pk_bf16_f32 v10, v20, v21
    v_cvt_pk_bf16_f32 v14, v28, v29
    v_cvt_pk_bf16_f32 v11, v22, v23
    v_cvt_pk_bf16_f32 v15, v30, v31
    s_and_saveexec_b64 s[30:31], vcc
    buffer_store_dwordx4 v[8:11], v40, s[20:23], 0 offen
    buffer_store_dwordx4 v[12:15], v40, s[24:27], 0 offen
    v_add_u32 v40, 896, v40
    v_add_u32 v7, 912, v7
    s_add_u32 s6, s6, 1
    s_cmp_lt_u32 s6, 8
    s_cbranch_scc1 row1_loop
row1_end:
    s_endpgm
.globl chain1_kernel
.p2align 8
.type chain1_kernel,@function
chain1_kernel:
    s_load_dwordx16 s[36:51], s[0:1], 0
    s_load_dwordx8 s[52:59], s[0:1], 64
    s_load_dwordx2 s[60:61], s[0:1], 104
    s_load_dwordx2 s[62:63], s[0:1], 120
    s_waitcnt lgkmcnt(0)
    s_cmp_ge_u32 s2, 64
    s_cbranch_scc1 c1_end
    s_add_u32 s4, s62, 16777216
    s_addc_u32 s5, s63, 0
    s_mov_b32 s6, 11010048
    s_mov_b32 s7, 0x20000
    s_add_u32 s8, s62, 29360128
    s_addc_u32 s9, s63, 0
    s_mov_b32 s10, 3670016
    s_mov_b32 s11, 0x20000
    s_add_u32 s12, s62, 33554432
    s_addc_u32 s13, s63, 0
    s_mov_b32 s14, 50331648
    s_mov_b32 s15, 0x20000
    s_add_u32 s16, s62, 119537664
    s_addc_u32 s17, s63, 0
    s_mov_b32 s18, 8388608
    s_mov_b32 s19, 0x20000
    s_add_u32 s20, s62, 134217728
    s_addc_u32 s21, s63, 0
    s_mov_b32 s22, 1048576
    s_mov_b32 s23, 0x20000
    s_add_u32 s24, s62, 135266304
    s_addc_u32 s25, s63, 0
    s_mov_b32 s26, 5242880
    s_mov_b32 s27, 0x20000
    s_add_u32 s28, s62, 140509184
    s_addc_u32 s29, s63, 0
    s_mov_b32 s30, 65536
    s_mov_b32 s31, 0x20000
    s_mov_b32 s64, s50
    s_mov_b32 s65, s51
    s_mov_b32 s66, 7168
    s_mov_b32 s67, 0x20000
    v_and_b32 v1, 15, v0
    v_bfe_u32 v2, v0, 4, 2
    v_lshrrev_b32 v3, 6, v0
    s_nop 1
    v_readfirstlane_b32 s68, v3
    s_lshl_b32 s69, s2, 6
    v_lshl_add_u32 v4, v3, 4, v1
    v_add_u32 v4, s69, v4
    v_mul_u32_u24 v4, 896, v4
    v_lshl_add_u32 v4, v2, 4, v4
    buffer_load_dwordx4 a[0:3], v4, s[4:7], 0 offen offset:0
    buffer_load_dwordx4 a[4:7], v4, s[4:7], 0 offen offset:64
    buffer_load_dwordx4 a[8:11], v4, s[4:7], 0 offen offset:128
    buffer_load_dwordx4 a[12:15], v4, s[4:7], 0 offen offset:192
    buffer_load_dwordx4 a[16:19], v4, s[4:7], 0 offen offset:256
    buffer_load_dwordx4 a[20:23], v4, s[4:7], 0 offen offset:320
    buffer_load_dwordx4 a[24:27], v4, s[4:7], 0 offen offset:384
    buffer_load_dwordx4 a[28:31], v4, s[4:7], 0 offen offset:448
    buffer_load_dwordx4 a[32:35], v4, s[4:7], 0 offen offset:512
    buffer_load_dwordx4 a[36:39], v4, s[4:7], 0 offen offset:576
    buffer_load_dwordx4 a[40:43], v4, s[4:7], 0 offen offset:640
    buffer_load_dwordx4 a[44:47], v4, s[4:7], 0 offen offset:704
    buffer_load_dwordx4 a[48:51], v4, s[4:7], 0 offen offset:768
    buffer_load_dwordx4 a[52:55], v4, s[4:7], 0 offen offset:832
    v_add_u32 v4, 0x380000, v4
    buffer_load_dwordx4 a[56:59], v4, s[4:7], 0 offen offset:0
    buffer_load_dwordx4 a[60:63], v4, s[4:7], 0 offen offset:64
    buffer_load_dwordx4 a[64:67], v4, s[4:7], 0 offen offset:128
    buffer_load_dwordx4 a[68:71], v4, s[4:7], 0 offen offset:192
    buffer_load_dwordx4 a[72:75], v4, s[4:7], 0 offen offset:256
    buffer_load_dwordx4 a[76:79], v4, s[4:7], 0 offen offset:320
    buffer_load_dwordx4 a[80:83], v4, s[4:7], 0 offen offset:384
    buffer_load_dwordx4 a[84:87], v4, s[4:7], 0 offen offset:448
    buffer_load_dwordx4 a[88:91], v4, s[4:7], 0 offen offset:512
    buffer_load_dwordx4 a[92:95], v4, s[4:7], 0 offen offset:576
    buffer_load_dwordx4 a[96:99], v4, s[4:7], 0 offen offset:640
    buffer_load_dwordx4 a[100:103], v4, s[4:7], 0 offen offset:704
    buffer_load_dwordx4 a[104:107], v4, s[4:7], 0 offen offset:768
    buffer_load_dwordx4 a[108:111], v4, s[4:7], 0 offen offset:832
    v_add_u32 v4, 0x380000, v4
    buffer_load_dwordx4 a[112:115], v4, s[4:7], 0 offen offset:0
    buffer_load_dwordx4 a[116:119], v4, s[4:7], 0 offen offset:64
    buffer_load_dwordx4 a[120:123], v4, s[4:7], 0 offen offset:128
    buffer_load_dwordx4 a[124:127], v4, s[4:7], 0 offen offset:192
    buffer_load_dwordx4 a[128:131], v4, s[4:7], 0 offen offset:256
    buffer_load_dwordx4 a[132:135], v4, s[4:7], 0 offen offset:320
    buffer_load_dwordx4 a[136:139], v4, s[4:7], 0 offen offset:384
    buffer_load_dwordx4 a[140:143], v4, s[4:7], 0 offen offset:448
    buffer_load_dwordx4 a[144:147], v4, s[4:7], 0 offen offset:512
    buffer_load_dwordx4 a[148:151], v4, s[4:7], 0 offen offset:576
    buffer_load_dwordx4 a[152:155], v4, s[4:7], 0 offen offset:640
    buffer_load_dwordx4 a[156:159], v4, s[4:7], 0 offen offset:704
    buffer_load_dwordx4 a[160:163], v4, s[4:7], 0 offen offset:768
    buffer_load_dwordx4 a[164:167], v4, s[4:7], 0 offen offset:832
    v_add_u32 v4, 0x380000, v4
    v_mul_u32_u24 v4, 112, v3
    v_add_u32 v4, v4, v1
    v_lshlrev_b32 v4, 13, v4
    v_lshl_add_u32 v4, v2, 4, v4
    s_lshl_b32 s70, s69, 1
    v_add_u32 v4, s70, v4
    buffer_load_dwordx4 a[168:171], v4, s[8:11], 0 offen offset:0
    buffer_load_dwordx4 a[172:175], v4, s[8:11], 0 offen offset:64
    v_add_u32 v4, 0x20000, v4
    buffer_load_dwordx4 a[176:179], v4, s[8:11], 0 offen offset:0
    buffer_load_dwordx4 a[180:183], v4, s[8:11], 0 offen offset:64
    v_add_u32 v4, 0x20000, v4
    buffer_load_dwordx4 a[184:187], v4, s[8:11], 0 offen offset:0
    buffer_load_dwordx4 a[188:191], v4, s[8:11], 0 offen offset:64
    v_add_u32 v4, 0x20000, v4
    buffer_load_dwordx4 a[192:195], v4, s[8:11], 0 offen offset:0
    buffer_load_dwordx4 a[196:199], v4, s[8:11], 0 offen offset:64
    v_add_u32 v4, 0x20000, v4
    buffer_load_dwordx4 a[200:203], v4, s[8:11], 0 offen offset:0
    buffer_load_dwordx4 a[204:207], v4, s[8:11], 0 offen offset:64
    v_add_u32 v4, 0x20000, v4
    buffer_load_dwordx4 a[208:211], v4, s[8:11], 0 offen offset:0
    buffer_load_dwordx4 a[212:215], v4, s[8:11], 0 offen offset:64
    v_add_u32 v4, 0x20000, v4
    buffer_load_dwordx4 a[216:219], v4, s[8:11], 0 offen offset:0
    buffer_load_dwordx4 a[220:223], v4, s[8:11], 0 offen offset:64
    v_add_u32 v4, 0x20000, v4
    v_mov_b32 v240, 0
    v_mov_b32 v241, 0
    v_mov_b32 v242, 0
    v_mov_b32 v243, 0
    v_lshlrev_b32 v5, 4, v0
    ds_write_b128 v5, v[240:243] offset:0
    ds_write_b128 v5, v[240:243] offset:4096
    ds_write_b128 v5, v[240:243] offset:8192
    ds_write_b128 v5, v[240:243] offset:12288
    v_and_b32 v6, 7, v0
    v_mul_u32_u24 v7, 896, v6
    v_lshl_add_u32 v7, v2, 4, v7
    buffer_load_dwordx4 v[176:179], v7, s[64:67], 0 offen offset:0
    buffer_load_dwordx4 v[180:183], v7, s[64:67], 0 offen offset:64
    buffer_load_dwordx4 v[184:187], v7, s[64:67], 0 offen offset:128
    buffer_load_dwordx4 v[188:191], v7, s[64:67], 0 offen offset:192
    buffer_load_dwordx4 v[192:195], v7, s[64:67], 0 offen offset:256
    buffer_load_dwordx4 v[196:199], v7, s[64:67], 0 offen offset:320
    buffer_load_dwordx4 v[200:203], v7, s[64:67], 0 offen offset:384
    buffer_load_dwordx4 v[204:207], v7, s[64:67], 0 offen offset:448
    buffer_load_dwordx4 v[208:211], v7, s[64:67], 0 offen offset:512
    buffer_load_dwordx4 v[212:215], v7, s[64:67], 0 offen offset:576
    buffer_load_dwordx4 v[216:219], v7, s[64:67], 0 offen offset:640
    buffer_load_dwordx4 v[220:223], v7, s[64:67], 0 offen offset:704
    buffer_load_dwordx4 v[224:227], v7, s[64:67], 0 offen offset:768
    buffer_load_dwordx4 v[228:231], v7, s[64:67], 0 offen offset:832
    s_waitcnt vmcnt(0) lgkmcnt(0)
    s_barrier
    s_mov_b32 s71, 0
c1_loop:
    s_add_u32 s72, s71, 65
    s_and_b32 s73, s71, 1
    v_mov_b32 v232, 0
    v_mov_b32 v233, 0
    v_mov_b32 v234, 0
    v_mov_b32 v235, 0
    v_mov_b32 v236, 0
    v_mov_b32 v237, 0
    v_mov_b32 v238, 0
    v_mov_b32 v239, 0
    v_mov_b32 v240, 0
    v_mov_b32 v241, 0
    v_mov_b32 v242, 0
    v_mov_b32 v243, 0
    s_nop 1
    s_mul_i32 s74, s71, 786432
    s_add_u32 s74, s74, s70
    v_lshrrev_b32 v244, 3, v0
    v_mul_u32_u24 v245, 24576, v244
    v_and_b32 v246, 7, v0
    v_lshl_add_u32 v245, v246, 4, v245
    buffer_load_dwordx4 v[120:123], v245, s[12:15], s74 offen offset:0
    v_mfma_f32_16x16x32_bf16 v[232:235], a[0:3], v[176:179], v[232:235]
    v_mfma_f32_16x16x32_bf16 v[236:239], a[56:59], v[176:179], v[236:239]
    v_mfma_f32_16x16x32_bf16 v[240:243], a[112:115], v[176:179], v[240:243]
    v_mfma_f32_16x16x32_bf16 v[232:235], a[4:7], v[180:183], v[232:235]
    v_mfma_f32_16x16x32_bf16 v[236:239], a[60:63], v[180:183], v[236:239]
    v_mfma_f32_16x16x32_bf16 v[240:243], a[116:119], v[180:183], v[240:243]
    v_mfma_f32_16x16x32_bf16 v[232:235], a[8:11], v[184:187], v[232:235]
    v_mfma_f32_16x16x32_bf16 v[236:239], a[64:67], v[184:187], v[236:239]
    v_mfma_f32_16x16x32_bf16 v[240:243], a[120:123], v[184:187], v[240:243]
    v_mfma_f32_16x16x32_bf16 v[232:235], a[12:15], v[188:191], v[232:235]
    v_mfma_f32_16x16x32_bf16 v[236:239], a[68:71], v[188:191], v[236:239]
    v_mfma_f32_16x16x32_bf16 v[240:243], a[124:127], v[188:191], v[240:243]
    v_mfma_f32_16x16x32_bf16 v[232:235], a[16:19], v[192:195], v[232:235]
    v_mfma_f32_16x16x32_bf16 v[236:239], a[72:75], v[192:195], v[236:239]
    v_mfma_f32_16x16x32_bf16 v[240:243], a[128:131], v[192:195], v[240:243]
    v_mfma_f32_16x16x32_bf16 v[232:235], a[20:23], v[196:199], v[232:235]
    v_mfma_f32_16x16x32_bf16 v[236:239], a[76:79], v[196:199], v[236:239]
    v_mfma_f32_16x16x32_bf16 v[240:243], a[132:135], v[196:199], v[240:243]
    v_mfma_f32_16x16x32_bf16 v[232:235], a[24:27], v[200:203], v[232:235]
    v_mfma_f32_16x16x32_bf16 v[236:239], a[80:83], v[200:203], v[236:239]
    v_mfma_f32_16x16x32_bf16 v[240:243], a[136:139], v[200:203], v[240:243]
    v_mfma_f32_16x16x32_bf16 v[232:235], a[28:31], v[204:207], v[232:235]
    v_mfma_f32_16x16x32_bf16 v[236:239], a[84:87], v[204:207], v[236:239]
    v_mfma_f32_16x16x32_bf16 v[240:243], a[140:143], v[204:207], v[240:243]
    v_mfma_f32_16x16x32_bf16 v[232:235], a[32:35], v[208:211], v[232:235]
    v_mfma_f32_16x16x32_bf16 v[236:239], a[88:91], v[208:211], v[236:239]
    v_mfma_f32_16x16x32_bf16 v[240:243], a[144:147], v[208:211], v[240:243]
    v_mfma_f32_16x16x32_bf16 v[232:235], a[36:39], v[212:215], v[232:235]
    v_mfma_f32_16x16x32_bf16 v[236:239], a[92:95], v[212:215], v[236:239]
    v_mfma_f32_16x16x32_bf16 v[240:243], a[148:151], v[212:215], v[240:243]
    v_mfma_f32_16x16x32_bf16 v[232:235], a[40:43], v[216:219], v[232:235]
    v_mfma_f32_16x16x32_bf16 v[236:239], a[96:99], v[216:219], v[236:239]
    v_mfma_f32_16x16x32_bf16 v[240:243], a[152:155], v[216:219], v[240:243]
    v_mfma_f32_16x16x32_bf16 v[232:235], a[44:47], v[220:223], v[232:235]
    v_mfma_f32_16x16x32_bf16 v[236:239], a[100:103], v[220:223], v[236:239]
    v_mfma_f32_16x16x32_bf16 v[240:243], a[156:159], v[220:223], v[240:243]
    v_mfma_f32_16x16x32_bf16 v[232:235], a[48:51], v[224:227], v[232:235]
    v_mfma_f32_16x16x32_bf16 v[236:239], a[104:107], v[224:227], v[236:239]
    v_mfma_f32_16x16x32_bf16 v[240:243], a[160:163], v[224:227], v[240:243]
    v_mfma_f32_16x16x32_bf16 v[232:235], a[52:55], v[228:231], v[232:235]
    v_mfma_f32_16x16x32_bf16 v[236:239], a[108:111], v[228:231], v[236:239]
    v_mfma_f32_16x16x32_bf16 v[240:243], a[164:167], v[228:231], v[240:243]
    s_nop 7
    v_cmp_gt_u32 vcc, 8, v1
    s_nop 1
    s_and_saveexec_b64 s[76:77], vcc
    v_cvt_pk_bf16_f32 v124, v232, v233
    v_cvt_pk_bf16_f32 v125, v234, v235
    v_cvt_pk_bf16_f32 v126, v236, v237
    v_cvt_pk_bf16_f32 v127, v238, v239
    v_cvt_pk_bf16_f32 v128, v240, v241
    v_cvt_pk_bf16_f32 v129, v242, v243
    v_lshlrev_b32 v247, 7, v1
    v_lshl_add_u32 v247, v3, 5, v247
    v_lshl_add_u32 v247, v2, 3, v247
    ds_write_b64 v247, v[124:125]
    ds_write_b64 v247, v[126:127] offset:1024
    v_lshlrev_b32 v248, 14, v1
    v_lshl_add_u32 v248, v3, 5, v248
    v_lshl_add_u32 v248, v2, 3, v248
    s_lshl_b32 s75, s71, 17
    s_add_u32 s75, s75, s70
    buffer_store_dwordx2 v[126:127], v248, s[16:19], s75 offen
    v_add_u32 v249, 8192, v248
    buffer_store_dwordx2 v[128:129], v249, s[16:19], s75 offen
    v_lshlrev_b32 v247, 2, v2
    v_lshl_add_u32 v247, v3, 4, v247
    v_mul_u32_u24 v247, 144, v247
    v_lshl_add_u32 v247, v1, 1, v247
    ds_write_b16 v247, v128 offset:2048
    ds_write_b16_d16_hi v247, v128 offset:2192
    ds_write_b16 v247, v129 offset:2336
    ds_write_b16_d16_hi v247, v129 offset:2480
    s_or_b64 exec, exec, s[76:77]
    v_add_u32 v245, 16384, v245
    buffer_load_dwordx4 v[120:123], v245, s[12:15], s74 offen
    s_waitcnt vmcnt(0)
    v_mul_u32_u24 v247, 1152, v246
    v_lshl_add_u32 v247, v244, 1, v247
    ds_write_b16 v247, v120 offset:2064
    ds_write_b16_d16_hi v247, v120 offset:2208
    ds_write_b16 v247, v121 offset:2352
    ds_write_b16_d16_hi v247, v121 offset:2496
    ds_write_b16 v247, v122 offset:2640
    ds_write_b16_d16_hi v247, v122 offset:2784
    ds_write_b16 v247, v123 offset:2928
    ds_write_b16_d16_hi v247, v123 offset:3072
    s_waitcnt lgkmcnt(0)
    s_barrier
    s_cmp_lg_u32 s68, 0
    s_cbranch_scc1 c1_skipS
    v_and_b32 v6, 7, v1
    v_lshlrev_b32 v247, 7, v6
    v_lshl_add_u32 v247, v2, 4, v247
    ds_read_b128 v[120:123], v247 offset:0
    ds_read_b128 v[128:131], v247 offset:1024
    ds_read_b128 v[124:127], v247 offset:64
    ds_read_b128 v[132:135], v247 offset:1088
    v_mul_u32_u24 v248, 24576, v1
    v_lshl_add_u32 v248, v2, 4, v248
    v_add_u32 v248, 8192, v248
    buffer_load_dwordx4 v[136:139], v248, s[12:15], s74 offen offset:0
    buffer_load_dwordx4 v[140:143], v248, s[12:15], s74 offen offset:64
    v_add_u32 v248, 393216, v248
    buffer_load_dwordx4 v[144:147], v248, s[12:15], s74 offen offset:0
    buffer_load_dwordx4 v[148:151], v248, s[12:15], s74 offen offset:64
    v_add_u32 v248, 393216, v248
    v_mov_b32 v232, 0
    v_mov_b32 v233, 0
    v_mov_b32 v234, 0
    v_mov_b32 v235, 0
    v_mov_b32 v236, 0
    v_mov_b32 v237, 0
    v_mov_b32 v238, 0
    v_mov_b32 v239, 0
    v_mov_b32 v240, 0
    v_mov_b32 v241, 0
    v_mov_b32 v242, 0
    v_mov_b32 v243, 0
    s_waitcnt vmcnt(0) lgkmcnt(0)
    v_mfma_f32_16x16x32_bf16 v[232:235], v[128:131], v[120:123], v[232:235]
    v_mfma_f32_16x16x32_bf16 v[232:235], v[132:135], v[124:127], v[232:235]
    v_mfma_f32_16x16x32_bf16 v[236:239], v[136:139], v[120:123], v[236:239]
    v_mfma_f32_16x16x32_bf16 v[236:239], v[140:143], v[124:127], v[236:239]
    v_mfma_f32_16x16x32_bf16 v[240:243], v[144:147], v[120:123], v[240:243]
    v_mfma_f32_16x16x32_bf16 v[240:243], v[148:151], v[124:127], v[240:243]
    s_nop 7
    s_lshl_b32 s78, s73, 6
    s_and_b32 s79, s2, 60
    s_add_u32 s79, s79, s78
    s_add_u32 s78, s78, s2
    s_mul_i32 s78, s78, 6144
    s_mul_i32 s79, s79, 6144
    v_and_b32 v247, 63, v0
    v_lshlrev_b32 v247, 5, v247
    v_mov_b32 v120, v232
    v_mov_b32 v121, s72
    v_mov_b32 v122, v233
    v_mov_b32 v123, s72
    buffer_store_dwordx4 v[120:123], v247, s[20:23], s78 offen offset:0 sc1
    s_nop 2
    v_mov_b32 v120, v234
    v_mov_b32 v121, s72
    v_mov_b32 v122, v235
    v_mov_b32 v123, s72
    buffer_store_dwordx4 v[120:123], v247, s[20:23], s78 offen offset:16 sc1
    s_nop 2
    v_mov_b32 v120, v236
    v_mov_b32 v121, s72
    v_mov_b32 v122, v237
    v_mov_b32 v123, s72
    buffer_store_dwordx4 v[120:123], v247, s[20:23], s78 offen offset:2048 sc1
    s_nop 2
    v_mov_b32 v120, v238
    v_mov_b32 v121, s72
    v_mov_b32 v122, v239
    v_mov_b32 v123, s72
    buffer_store_dwordx4 v[120:123], v247, s[20:23], s78 offen offset:2064 sc1
    s_nop 2
    v_mov_b32 v120, v240
    v_mov_b32 v121, s72
    v_mov_b32 v122, v241
    v_mov_b32 v123, s72
    buffer_store_dwordx4 v[120:123], v247, s[20:23], s78 offen offset:4096 sc1
    s_nop 2
    v_mov_b32 v120, v242
    v_mov_b32 v121, s72
    v_mov_b32 v122, v243
    v_mov_b32 v123, s72
    buffer_store_dwordx4 v[120:123], v247, s[20:23], s78 offen offset:4112 sc1
    s_nop 2
    s_mov_b32 s33, 0
p4330:
    buffer_load_dwordx4 v[8:11], v247, s[20:23], s79 offen offset:0 sc1
    buffer_load_dwordx4 v[12:15], v247, s[20:23], s79 offen offset:16 sc1
    buffer_load_dwordx4 v[16:19], v247, s[20:23], s79 offen offset:2048 sc1
    buffer_load_dwordx4 v[20:23], v247, s[20:23], s79 offen offset:2064 sc1
    buffer_load_dwordx4 v[24:27], v247, s[20:23], s79 offen offset:4096 sc1
    buffer_load_dwordx4 v[28:31], v247, s[20:23], s79 offen offset:4112 sc1
    s_add_u32 s79, s79, 6144
    buffer_load_dwordx4 v[32:35], v247, s[20:23], s79 offen offset:0 sc1
    buffer_load_dwordx4 v[36:39], v247, s[20:23], s79 offen offset:16 sc1
    buffer_load_dwordx4 v[40:43], v247, s[20:23], s79 offen offset:2048 sc1
    buffer_load_dwordx4 v[44:47], v247, s[20:23], s79 offen offset:2064 sc1
    buffer_load_dwordx4 v[48:51], v247, s[20:23], s79 offen offset:4096 sc1
    buffer_load_dwordx4 v[52:55], v247, s[20:23], s79 offen offset:4112 sc1
    s_add_u32 s79, s79, 6144
    buffer_load_dwordx4 v[56:59], v247, s[20:23], s79 offen offset:0 sc1
    buffer_load_dwordx4 v[60:63], v247, s[20:23], s79 offen offset:16 sc1
    buffer_load_dwordx4 v[64:67], v247, s[20:23], s79 offen offset:2048 sc1
    buffer_load_dwordx4 v[68:71], v247, s[20:23], s79 offen offset:2064 sc1
    buffer_load_dwordx4 v[72:75], v247, s[20:23], s79 offen offset:4096 sc1
    buffer_load_dwordx4 v[76:79], v247, s[20:23], s79 offen offset:4112 sc1
    s_add_u32 s79, s79, 6144
    buffer_load_dwordx4 v[80:83], v247, s[20:23], s79 offen offset:0 sc1
    buffer_load_dwordx4 v[84:87], v247, s[20:23], s79 offen offset:16 sc1
    buffer_load_dwordx4 v[88:91], v247, s[20:23], s79 offen offset:2048 sc1
    buffer_load_dwordx4 v[92:95], v247, s[20:23], s79 offen offset:2064 sc1
    buffer_load_dwordx4 v[96:99], v247, s[20:23], s79 offen offset:4096 sc1
    buffer_load_dwordx4 v[100:103], v247, s[20:23], s79 offen offset:4112 sc1
    s_add_u32 s79, s79, 6144
    s_sub_u32 s79, s79, 24576
    s_waitcnt vmcnt(0)
    v_xor_b32 v250, s72, v9
    v_xor_b32 v251, s72, v11
    v_or_b32 v250, v250, v251
    v_xor_b32 v251, s72, v13
    v_or_b32 v250, v250, v251
    v_xor_b32 v251, s72, v15
    v_or_b32 v250, v250, v251
    v_xor_b32 v251, s72, v17
    v_or_b32 v250, v250, v251
    v_xor_b32 v251, s72, v19
    v_or_b32 v250, v250, v251
    v_xor_b32 v251, s72, v21
    v_or_b32 v250, v250, v251
    v_xor_b32 v251, s72, v23
    v_or_b32 v250, v250, v251
    v_xor_b32 v251, s72, v25
    v_or_b32 v250, v250, v251
    v_xor_b32 v251, s72, v27
    v_or_b32 v250, v250, v251
    v_xor_b32 v251, s72, v29
    v_or_b32 v250, v250, v251
    v_xor_b32 v251, s72, v31
    v_or_b32 v250, v250, v251
    v_xor_b32 v251, s72, v33
    v_or_b32 v250, v250, v251
    v_xor_b32 v251, s72, v35
    v_or_b32 v250, v250, v251
    v_xor_b32 v251, s72, v37
    v_or_b32 v250, v250, v251
    v_xor_b32 v251, s72, v39
    v_or_b32 v250, v250, v251
    v_xor_b32 v251, s72, v41
    v_or_b32 v250, v250, v251
    v_xor_b32 v251, s72, v43
    v_or_b32 v250, v250, v251
    v_xor_b32 v251, s72, v45
    v_or_b32 v250, v250, v251
    v_xor_b32 v251, s72, v47
    v_or_b32 v250, v250, v251
    v_xor_b32 v251, s72, v49
    v_or_b32 v250, v250, v251
    v_xor_b32 v251, s72, v51
    v_or_b32 v250, v250, v251
    v_xor_b32 v251, s72, v53
    v_or_b32 v250, v250, v251
    v_xor_b32 v251, s72, v55
    v_or_b32 v250, v250, v251
    v_xor_b32 v251, s72, v57
    v_or_b32 v250, v250, v251
    v_xor_b32 v251, s72, v59
    v_or_b32 v250, v250, v251
    v_xor_b32 v251, s72, v61
    v_or_b32 v250, v250, v251
    v_xor_b32 v251, s72, v63
    v_or_b32 v250, v250, v251
    v_xor_b32 v251, s72, v65
    v_or_b32 v250, v250, v251
    v_xor_b32 v251, s72, v67
    v_or_b32 v250, v250, v251
    v_xor_b32 v251, s72, v69
    v_or_b32 v250, v250, v251
    v_xor_b32 v251, s72, v71
    v_or_b32 v250, v250, v251
    v_xor_b32 v251, s72, v73
    v_or_b32 v250, v250, v251
    v_xor_b32 v251, s72, v75
    v_or_b32 v250, v250, v251
    v_xor_b32 v251, s72, v77
    v_or_b32 v250, v250, v251
    v_xor_b32 v251, s72, v79
    v_or_b32 v250, v250, v251
    v_xor_b32 v251, s72, v81
    v_or_b32 v250, v250, v251
    v_xor_b32 v251, s72, v83
    v_or_b32 v250, v250, v251
    v_xor_b32 v251, s72, v85
    v_or_b32 v250, v250, v251
    v_xor_b32 v251, s72, v87
    v_or_b32 v250, v250, v251
    v_xor_b32 v251, s72, v89
    v_or_b32 v250, v250, v251
    v_xor_b32 v251, s72, v91
    v_or_b32 v250, v250, v251
    v_xor_b32 v251, s72, v93
    v_or_b32 v250, v250, v251
    v_xor_b32 v251, s72, v95
    v_or_b32 v250, v250, v251
    v_xor_b32 v251, s72, v97
    v_or_b32 v250, v250, v251
    v_xor_b32 v251, s72, v99
    v_or_b32 v250, v250, v251
    v_xor_b32 v251, s72, v101
    v_or_b32 v250, v250, v251
    v_xor_b32 v251, s72, v103
    v_or_b32 v250, v250, v251
    v_cmp_ne_u32 vcc, 0, v250
    s_add_u32 s33, s33, 1
    s_cmp_gt_u32 s33, 400000
    s_cbranch_scc1 p4330x
    s_nop 3
    s_cbranch_vccnz p4330
p4330x:
    v_add_f32 v232, v8, v32
    v_add_f32 v232, v232, v56
    v_add_f32 v232, v232, v80
    v_cvt_pk_bf16_f32 v232, v232, v232
    v_lshlrev_b32 v232, 16, v232
    v_mul_f32 v232, 0x3d800000, v232
    v_add_f32 v233, v10, v34
    v_add_f32 v233, v233, v58
    v_add_f32 v233, v233, v82
    v_cvt_pk_bf16_f32 v233, v233, v233
    v_lshlrev_b32 v233, 16, v233
    v_mul_f32 v233, 0x3d800000, v233
    v_add_f32 v234, v12, v36
    v_add_f32 v234, v234, v60
    v_add_f32 v234, v234, v84
    v_cvt_pk_bf16_f32 v234, v234, v234
    v_lshlrev_b32 v234, 16, v234
    v_mul_f32 v234, 0x3d800000, v234
    v_add_f32 v235, v14, v38
    v_add_f32 v235, v235, v62
    v_add_f32 v235, v235, v86
    v_cvt_pk_bf16_f32 v235, v235, v235
    v_lshlrev_b32 v235, 16, v235
    v_mul_f32 v235, 0x3d800000, v235
    v_add_f32 v236, v16, v40
    v_add_f32 v236, v236, v64
    v_add_f32 v236, v236, v88
    v_cvt_pk_bf16_f32 v236, v236, v236
    v_lshlrev_b32 v236, 16, v236
    v_mul_f32 v236, 0x3d800000, v236
    v_add_f32 v237, v18, v42
    v_add_f32 v237, v237, v66
    v_add_f32 v237, v237, v90
    v_cvt_pk_bf16_f32 v237, v237, v237
    v_lshlrev_b32 v237, 16, v237
    v_mul_f32 v237, 0x3d800000, v237
    v_add_f32 v238, v20, v44
    v_add_f32 v238, v238, v68
    v_add_f32 v238, v238, v92
    v_cvt_pk_bf16_f32 v238, v238, v238
    v_lshlrev_b32 v238, 16, v238
    v_mul_f32 v238, 0x3d800000, v238
    v_add_f32 v239, v22, v46
    v_add_f32 v239, v239, v70
    v_add_f32 v239, v239, v94
    v_cvt_pk_bf16_f32 v239, v239, v239
    v_lshlrev_b32 v239, 16, v239
    v_mul_f32 v239, 0x3d800000, v239
    v_add_f32 v240, v24, v48
    v_add_f32 v240, v240, v72
    v_add_f32 v240, v240, v96
    v_cvt_pk_bf16_f32 v240, v240, v240
    v_lshlrev_b32 v240, 16, v240
    v_mul_f32 v240, 0x3d800000, v240
    v_add_f32 v241, v26, v50
    v_add_f32 v241, v241, v74
    v_add_f32 v241, v241, v98
    v_cvt_pk_bf16_f32 v241, v241, v241
    v_lshlrev_b32 v241, 16, v241
    v_mul_f32 v241, 0x3d800000, v241
    v_add_f32 v242, v28, v52
    v_add_f32 v242, v242, v76
    v_add_f32 v242, v242, v100
    v_cvt_pk_bf16_f32 v242, v242, v242
    v_lshlrev_b32 v242, 16, v242
    v_mul_f32 v242, 0x3d800000, v242
    v_add_f32 v243, v30, v54
    v_add_f32 v243, v243, v78
    v_add_f32 v243, v243, v102
    v_cvt_pk_bf16_f32 v243, v243, v243
    v_lshlrev_b32 v243, 16, v243
    v_mul_f32 v243, 0x3d800000, v243
    v_cmp_lt_u32 vcc, 1, v2
    v_mov_b32 v248, 0xff800000
    s_nop 1
    v_cndmask_b32 v232, v232, v248, vcc
    v_cndmask_b32 v233, v233, v248, vcc
    v_cndmask_b32 v234, v234, v248, vcc
    v_cndmask_b32 v235, v235, v248, vcc
    v_max_f32 v249, v232, v233
    v_max_f32 v249, v249, v234
    v_max_f32 v249, v249, v235
    v_max_f32 v249, v249, v236
    v_max_f32 v249, v249, v237
    v_max_f32 v249, v249, v238
    v_max_f32 v249, v249, v239
    v_max_f32 v249, v249, v240
    v_max_f32 v249, v249, v241
    v_max_f32 v249, v249, v242
    v_max_f32 v249, v249, v243
    v_and_b32 v247, 63, v0
    v_xor_b32 v244, 16, v247
    v_lshlrev_b32 v244, 2, v244
    v_xor_b32 v245, 32, v247
    v_lshlrev_b32 v245, 2, v245
    ds_bpermute_b32 v248, v244, v249
    s_waitcnt lgkmcnt(0)
    v_max_f32 v249, v249, v248
    ds_bpermute_b32 v248, v245, v249
    s_waitcnt lgkmcnt(0)
    v_max_f32 v249, v249, v248
    v_sub_f32 v232, v232, v249
    v_mul_f32 v232, 0x3fb8aa3b, v232
    v_exp_f32 v232, v232
    v_sub_f32 v233, v233, v249
    v_mul_f32 v233, 0x3fb8aa3b, v233
    v_exp_f32 v233, v233
    v_sub_f32 v234, v234, v249
    v_mul_f32 v234, 0x3fb8aa3b, v234
    v_exp_f32 v234, v234
    v_sub_f32 v235, v235, v249
    v_mul_f32 v235, 0x3fb8aa3b, v235
    v_exp_f32 v235, v235
    v_sub_f32 v236, v236, v249
    v_mul_f32 v236, 0x3fb8aa3b, v236
    v_exp_f32 v236, v236
    v_sub_f32 v237, v237, v249
    v_mul_f32 v237, 0x3fb8aa3b, v237
    v_exp_f32 v237, v237
    v_sub_f32 v238, v238, v249
    v_mul_f32 v238, 0x3fb8aa3b, v238
    v_exp_f32 v238, v238
    v_sub_f32 v239, v239, v249
    v_mul_f32 v239, 0x3fb8aa3b, v239
    v_exp_f32 v239, v239
    v_sub_f32 v240, v240, v249
    v_mul_f32 v240, 0x3fb8aa3b, v240
    v_exp_f32 v240, v240
    v_sub_f32 v241, v241, v249
    v_mul_f32 v241, 0x3fb8aa3b, v241
    v_exp_f32 v241, v241
    v_sub_f32 v242, v242, v249
    v_mul_f32 v242, 0x3fb8aa3b, v242
    v_exp_f32 v242, v242
    v_sub_f32 v243, v243, v249
    v_mul_f32 v243, 0x3fb8aa3b, v243
    v_exp_f32 v243, v243
    s_nop 1
    v_add_f32 v249, v232, v233
    v_add_f32 v249, v249, v234
    v_add_f32 v249, v249, v235
    v_add_f32 v249, v249, v236
    v_add_f32 v249, v249, v237
    v_add_f32 v249, v249, v238
    v_add_f32 v249, v249, v239
    v_add_f32 v249, v249, v240
    v_add_f32 v249, v249, v241
    v_add_f32 v249, v249, v242
    v_add_f32 v249, v249, v243
    ds_bpermute_b32 v248, v244, v249
    s_waitcnt lgkmcnt(0)
    v_add_f32 v249, v249, v248
    ds_bpermute_b32 v248, v245, v249
    s_waitcnt lgkmcnt(0)
    v_add_f32 v249, v249, v248
    v_rcp_f32 v249, v249
    s_nop 1
    v_mul_f32 v232, v232, v249
    v_mul_f32 v233, v233, v249
    v_mul_f32 v234, v234, v249
    v_mul_f32 v235, v235, v249
    v_mul_f32 v236, v236, v249
    v_mul_f32 v237, v237, v249
    v_mul_f32 v238, v238, v249
    v_mul_f32 v239, v239, v249
    v_mul_f32 v240, v240, v249
    v_mul_f32 v241, v241, v249
    v_mul_f32 v242, v242, v249
    v_mul_f32 v243, v243, v249
    v_cmp_gt_u32 vcc, 8, v1
    s_nop 1
    s_and_saveexec_b64 s[76:77], vcc
    v_lshlrev_b32 v247, 7, v1
    v_lshl_add_u32 v247, v2, 3, v247
    v_cvt_pk_bf16_f32 v120, v232, v233
    v_cvt_pk_bf16_f32 v121, v234, v235
    v_cmp_gt_u32 vcc, 2, v2
    s_nop 1
    s_and_saveexec_b64 s[80:81], vcc
    ds_write_b64 v247, v[120:121] offset:11264
    s_or_b64 exec, exec, s[80:81]
    s_nop 1
    v_cvt_pk_bf16_f32 v120, v236, v237
    v_cvt_pk_bf16_f32 v121, v238, v239
    ds_write_b64 v247, v[120:121] offset:11280
    s_nop 1
    v_cvt_pk_bf16_f32 v120, v240, v241
    v_cvt_pk_bf16_f32 v121, v242, v243
    ds_write_b64 v247, v[120:121] offset:11312
    s_nop 1
    s_or_b64 exec, exec, s[76:77]
c1_skipS:
    s_waitcnt lgkmcnt(0)
    s_barrier
    v_lshl_add_u32 v247, v3, 4, v1
    v_mul_u32_u24 v247, 144, v247
    v_lshl_add_u32 v247, v2, 4, v247
    v_and_b32 v6, 7, v1
    v_lshlrev_b32 v248, 7, v6
    v_lshl_add_u32 v248, v2, 4, v248
    ds_read_b128 v[120:123], v247 offset:2048
    ds_read_b128 v[128:131], v248 offset:11264
    ds_read_b128 v[124:127], v247 offset:2112
    ds_read_b128 v[132:135], v248 offset:11328
    v_mov_b32 v232, 0
    v_mov_b32 v233, 0
    v_mov_b32 v234, 0
    v_mov_b32 v235, 0
    s_waitcnt lgkmcnt(0)
    v_mfma_f32_16x16x32_bf16 v[232:235], v[120:123], v[128:131], v[232:235]
    v_mfma_f32_16x16x32_bf16 v[232:235], v[124:127], v[132:135], v[232:235]
    s_nop 7
    v_cvt_pk_bf16_f32 v120, v232, v233
    v_cvt_pk_bf16_f32 v121, v234, v235
    v_cmp_gt_u32 vcc, 8, v1
    s_nop 1
    s_and_saveexec_b64 s[76:77], vcc
    v_lshlrev_b32 v247, 7, v1
    v_lshl_add_u32 v247, v3, 5, v247
    v_lshl_add_u32 v247, v2, 3, v247
    ds_write_b64 v247, v[120:121] offset:12288
    s_or_b64 exec, exec, s[76:77]
    s_waitcnt lgkmcnt(0)
    s_barrier
    ds_read_b128 v[128:131], v248 offset:12288
    ds_read_b128 v[132:135], v248 offset:12352
    v_mov_b32 v8, 0
    v_mov_b32 v9, 0
    v_mov_b32 v10, 0
    v_mov_b32 v11, 0
    v_mov_b32 v12, 0
    v_mov_b32 v13, 0
    v_mov_b32 v14, 0
    v_mov_b32 v15, 0
    v_mov_b32 v16, 0
    v_mov_b32 v17, 0
    v_mov_b32 v18, 0
    v_mov_b32 v19, 0
    v_mov_b32 v20, 0
    v_mov_b32 v21, 0
    v_mov_b32 v22, 0
    v_mov_b32 v23, 0
    v_mov_b32 v24, 0
    v_mov_b32 v25, 0
    v_mov_b32 v26, 0
    v_mov_b32 v27, 0
    v_mov_b32 v28, 0
    v_mov_b32 v29, 0
    v_mov_b32 v30, 0
    v_mov_b32 v31, 0
    v_mov_b32 v32, 0
    v_mov_b32 v33, 0
    v_mov_b32 v34, 0
    v_mov_b32 v35, 0
    s_waitcnt lgkmcnt(0)
    v_mfma_f32_16x16x32_bf16 v[8:11], a[168:171], v[128:131], v[8:11]
    v_mfma_f32_16x16x32_bf16 v[8:11], a[172:175], v[132:135], v[8:11]
    v_mfma_f32_16x16x32_bf16 v[12:15], a[176:179], v[128:131], v[12:15]
    v_mfma_f32_16x16x32_bf16 v[12:15], a[180:183], v[132:135], v[12:15]
    v_mfma_f32_16x16x32_bf16 v[16:19], a[184:187], v[128:131], v[16:19]
    v_mfma_f32_16x16x32_bf16 v[16:19], a[188:191], v[132:135], v[16:19]
    v_mfma_f32_16x16x32_bf16 v[20:23], a[192:195], v[128:131], v[20:23]
    v_mfma_f32_16x16x32_bf16 v[20:23], a[196:199], v[132:135], v[20:23]
    v_mfma_f32_16x16x32_bf16 v[24:27], a[200:203], v[128:131], v[24:27]
    v_mfma_f32_16x16x32_bf16 v[24:27], a[204:207], v[132:135], v[24:27]
    v_mfma_f32_16x16x32_bf16 v[28:31], a[208:211], v[128:131], v[28:31]
    v_mfma_f32_16x16x32_bf16 v[28:31], a[212:215], v[132:135], v[28:31]
    v_mfma_f32_16x16x32_bf16 v[32:35], a[216:219], v[128:131], v[32:35]
    v_mfma_f32_16x16x32_bf16 v[32:35], a[220:223], v[132:135], v[32:35]
    s_nop 7
    s_lshl_b32 s78, s73, 6
    s_add_u32 s79, s78, s2
    s_mul_i32 s79, s79, 28672
    v_cmp_gt_u32 vcc, 8, v1
    s_nop 1
    s_and_saveexec_b64 s[76:77], vcc
    v_mul_u32_u24 v247, 3584, v1
    v_mul_u32_u24 v248, 896, v3
    v_add_u32 v247, v247, v248
    v_lshl_add_u32 v247, v2, 5, v247
    v_mov_b32 v120, v8
    v_mov_b32 v121, s72
    v_mov_b32 v122, v9
    v_mov_b32 v123, s72
    buffer_store_dwordx4 v[120:123], v247, s[24:27], s79 offen offset:0 sc1
    s_nop 2
    v_mov_b32 v120, v10
    v_mov_b32 v121, s72
    v_mov_b32 v122, v11
    v_mov_b32 v123, s72
    buffer_store_dwordx4 v[120:123], v247, s[24:27], s79 offen offset:16 sc1
    s_nop 2
    v_mov_b32 v120, v12
    v_mov_b32 v121, s72
    v_mov_b32 v122, v13
    v_mov_b32 v123, s72
    buffer_store_dwordx4 v[120:123], v247, s[24:27], s79 offen offset:128 sc1
    s_nop 2
    v_mov_b32 v120, v14
    v_mov_b32 v121, s72
    v_mov_b32 v122, v15
    v_mov_b32 v123, s72
    buffer_store_dwordx4 v[120:123], v247, s[24:27], s79 offen offset:144 sc1
    s_nop 2
    v_mov_b32 v120, v16
    v_mov_b32 v121, s72
    v_mov_b32 v122, v17
    v_mov_b32 v123, s72
    buffer_store_dwordx4 v[120:123], v247, s[24:27], s79 offen offset:256 sc1
    s_nop 2
    v_mov_b32 v120, v18
    v_mov_b32 v121, s72
    v_mov_b32 v122, v19
    v_mov_b32 v123, s72
    buffer_store_dwordx4 v[120:123], v247, s[24:27], s79 offen offset:272 sc1
    s_nop 2
    v_mov_b32 v120, v20
    v_mov_b32 v121, s72
    v_mov_b32 v122, v21
    v_mov_b32 v123, s72
    buffer_store_dwordx4 v[120:123], v247, s[24:27], s79 offen offset:384 sc1
    s_nop 2
    v_mov_b32 v120, v22
    v_mov_b32 v121, s72
    v_mov_b32 v122, v23
    v_mov_b32 v123, s72
    buffer_store_dwordx4 v[120:123], v247, s[24:27], s79 offen offset:400 sc1
    s_nop 2
    v_mov_b32 v120, v24
    v_mov_b32 v121, s72
    v_mov_b32 v122, v25
    v_mov_b32 v123, s72
    buffer_store_dwordx4 v[120:123], v247, s[24:27], s79 offen offset:512 sc1
    s_nop 2
    v_mov_b32 v120, v26
    v_mov_b32 v121, s72
    v_mov_b32 v122, v27
    v_mov_b32 v123, s72
    buffer_store_dwordx4 v[120:123], v247, s[24:27], s79 offen offset:528 sc1
    s_nop 2
    v_mov_b32 v120, v28
    v_mov_b32 v121, s72
    v_mov_b32 v122, v29
    v_mov_b32 v123, s72
    buffer_store_dwordx4 v[120:123], v247, s[24:27], s79 offen offset:640 sc1
    s_nop 2
    v_mov_b32 v120, v30
    v_mov_b32 v121, s72
    v_mov_b32 v122, v31
    v_mov_b32 v123, s72
    buffer_store_dwordx4 v[120:123], v247, s[24:27], s79 offen offset:656 sc1
    s_nop 2
    v_mov_b32 v120, v32
    v_mov_b32 v121, s72
    v_mov_b32 v122, v33
    v_mov_b32 v123, s72
    buffer_store_dwordx4 v[120:123], v247, s[24:27], s79 offen offset:768 sc1
    s_nop 2
    v_mov_b32 v120, v34
    v_mov_b32 v121, s72
    v_mov_b32 v122, v35
    v_mov_b32 v123, s72
    buffer_store_dwordx4 v[120:123], v247, s[24:27], s79 offen offset:784 sc1
    s_nop 2
    s_or_b64 exec, exec, s[76:77]
    s_cmp_ge_u32 s2, 56
    s_cbranch_scc1 c1_nored
    s_lshl_b32 s79, s68, 4
    s_add_u32 s79, s79, s78
    s_mul_i32 s79, s79, 28672
    s_lshl_b32 s80, s2, 6
    s_add_u32 s79, s79, s80
    v_and_b32 v247, 31, v0
    v_lshrrev_b32 v248, 2, v247
    v_mul_u32_u24 v248, 3584, v248
    v_and_b32 v247, 3, v247
    v_lshl_add_u32 v247, v247, 4, v248
    s_mov_b32 s33, 0
p4841:
    buffer_load_dwordx4 v[8:11], v247, s[24:27], s79 offen sc1
    s_add_u32 s79, s79, 28672
    buffer_load_dwordx4 v[12:15], v247, s[24:27], s79 offen sc1
    s_add_u32 s79, s79, 28672
    buffer_load_dwordx4 v[16:19], v247, s[24:27], s79 offen sc1
    s_add_u32 s79, s79, 28672
    buffer_load_dwordx4 v[20:23], v247, s[24:27], s79 offen sc1
    s_add_u32 s79, s79, 28672
    buffer_load_dwordx4 v[24:27], v247, s[24:27], s79 offen sc1
    s_add_u32 s79, s79, 28672
    buffer_load_dwordx4 v[28:31], v247, s[24:27], s79 offen sc1
    s_add_u32 s79, s79, 28672
    buffer_load_dwordx4 v[32:35], v247, s[24:27], s79 offen sc1
    s_add_u32 s79, s79, 28672
    buffer_load_dwordx4 v[36:39], v247, s[24:27], s79 offen sc1
    s_add_u32 s79, s79, 28672
    buffer_load_dwordx4 v[40:43], v247, s[24:27], s79 offen sc1
    s_add_u32 s79, s79, 28672
    buffer_load_dwordx4 v[44:47], v247, s[24:27], s79 offen sc1
    s_add_u32 s79, s79, 28672
    buffer_load_dwordx4 v[48:51], v247, s[24:27], s79 offen sc1
    s_add_u32 s79, s79, 28672
    buffer_load_dwordx4 v[52:55], v247, s[24:27], s79 offen sc1
    s_add_u32 s79, s79, 28672
    buffer_load_dwordx4 v[56:59], v247, s[24:27], s79 offen sc1
    s_add_u32 s79, s79, 28672
    buffer_load_dwordx4 v[60:63], v247, s[24:27], s79 offen sc1
    s_add_u32 s79, s79, 28672
    buffer_load_dwordx4 v[64:67], v247, s[24:27], s79 offen sc1
    s_add_u32 s79, s79, 28672
    buffer_load_dwordx4 v[68:71], v247, s[24:27], s79 offen sc1
    s_add_u32 s79, s79, 28672
    s_sub_u32 s79, s79, 458752
    s_waitcnt vmcnt(0)
    v_xor_b32 v250, s72, v9
    v_xor_b32 v251, s72, v11
    v_or_b32 v250, v250, v251
    v_xor_b32 v251, s72, v13
    v_or_b32 v250, v250, v251
    v_xor_b32 v251, s72, v15
    v_or_b32 v250, v250, v251
    v_xor_b32 v251, s72, v17
    v_or_b32 v250, v250, v251
    v_xor_b32 v251, s72, v19
    v_or_b32 v250, v250, v251
    v_xor_b32 v251, s72, v21
    v_or_b32 v250, v250, v251
    v_xor_b32 v251, s72, v23
    v_or_b32 v250, v250, v251
    v_xor_b32 v251, s72, v25
    v_or_b32 v250, v250, v251
    v_xor_b32 v251, s72, v27
    v_or_b32 v250, v250, v251
    v_xor_b32 v251, s72, v29
    v_or_b32 v250, v250, v251
    v_xor_b32 v251, s72, v31
    v_or_b32 v250, v250, v251
    v_xor_b32 v251, s72, v33
    v_or_b32 v250, v250, v251
    v_xor_b32 v251, s72, v35
    v_or_b32 v250, v250, v251
    v_xor_b32 v251, s72, v37
    v_or_b32 v250, v250, v251
    v_xor_b32 v251, s72, v39
    v_or_b32 v250, v250, v251
    v_xor_b32 v251, s72, v41
    v_or_b32 v250, v250, v251
    v_xor_b32 v251, s72, v43
    v_or_b32 v250, v250, v251
    v_xor_b32 v251, s72, v45
    v_or_b32 v250, v250, v251
    v_xor_b32 v251, s72, v47
    v_or_b32 v250, v250, v251
    v_xor_b32 v251, s72, v49
    v_or_b32 v250, v250, v251
    v_xor_b32 v251, s72, v51
    v_or_b32 v250, v250, v251
    v_xor_b32 v251, s72, v53
    v_or_b32 v250, v250, v251
    v_xor_b32 v251, s72, v55
    v_or_b32 v250, v250, v251
    v_xor_b32 v251, s72, v57
    v_or_b32 v250, v250, v251
    v_xor_b32 v251, s72, v59
    v_or_b32 v250, v250, v251
    v_xor_b32 v251, s72, v61
    v_or_b32 v250, v250, v251
    v_xor_b32 v251, s72, v63
    v_or_b32 v250, v250, v251
    v_xor_b32 v251, s72, v65
    v_or_b32 v250, v250, v251
    v_xor_b32 v251, s72, v67
    v_or_b32 v250, v250, v251
    v_xor_b32 v251, s72, v69
    v_or_b32 v250, v250, v251
    v_xor_b32 v251, s72, v71
    v_or_b32 v250, v250, v251
    v_cmp_ne_u32 vcc, 0, v250
    s_add_u32 s33, s33, 1
    s_cmp_gt_u32 s33, 400000
    s_cbranch_scc1 p4841x
    s_nop 3
    s_cbranch_vccnz p4841
p4841x:
    v_add_f32 v8, v8, v12
    v_add_f32 v10, v10, v14
    v_add_f32 v8, v8, v16
    v_add_f32 v10, v10, v18
    v_add_f32 v8, v8, v20
    v_add_f32 v10, v10, v22
    v_add_f32 v8, v8, v24
    v_add_f32 v10, v10, v26
    v_add_f32 v8, v8, v28
    v_add_f32 v10, v10, v30
    v_add_f32 v8, v8, v32
    v_add_f32 v10, v10, v34
    v_add_f32 v8, v8, v36
    v_add_f32 v10, v10, v38
    v_add_f32 v8, v8, v40
    v_add_f32 v10, v10, v42
    v_add_f32 v8, v8, v44
    v_add_f32 v10, v10, v46
    v_add_f32 v8, v8, v48
    v_add_f32 v10, v10, v50
    v_add_f32 v8, v8, v52
    v_add_f32 v10, v10, v54
    v_add_f32 v8, v8, v56
    v_add_f32 v10, v10, v58
    v_add_f32 v8, v8, v60
    v_add_f32 v10, v10, v62
    v_add_f32 v8, v8, v64
    v_add_f32 v10, v10, v66
    v_add_f32 v8, v8, v68
    v_add_f32 v10, v10, v70
    v_mov_b32 v9, v10
    v_and_b32 v248, 31, v0
    v_lshlrev_b32 v248, 3, v248
    v_lshl_add_u32 v248, v3, 8, v248
    ds_write_b64 v248, v[8:9] offset:13312
    s_waitcnt lgkmcnt(0)
c1_nored:
    s_barrier
    s_cmp_ge_u32 s2, 56
    s_cbranch_scc1 c1_nored2
    v_and_b32 v248, 31, v0
    v_lshlrev_b32 v248, 3, v248
    ds_read_b64 v[8:9], v248 offset:13312
    ds_read_b64 v[10:11], v248 offset:13568
    ds_read_b64 v[12:13], v248 offset:13824
    ds_read_b64 v[14:15], v248 offset:14080
    s_waitcnt lgkmcnt(0)
    v_add_f32 v8, v8, v10
    v_add_f32 v9, v9, v11
    v_add_f32 v8, v8, v12
    v_add_f32 v9, v9, v13
    v_add_f32 v8, v8, v14
    v_add_f32 v9, v9, v15
    v_cvt_pk_bf16_f32 v8, v8, v9
    v_mov_b32 v9, s72
    v_and_b32 v247, 31, v0
    v_lshrrev_b32 v248, 2, v247
    v_mul_u32_u24 v248, 1792, v248
    v_and_b32 v247, 3, v247
    v_lshl_add_u32 v247, v247, 3, v248
    s_mul_i32 s79, s73, 14336
    s_lshl_b32 s80, s2, 5
    s_add_u32 s79, s79, s80
    buffer_store_dwordx2 v[8:9], v247, s[28:31], s79 offen sc1
c1_nored2:
    s_mul_i32 s79, s73, 14336
    v_and_b32 v6, 7, v1
    v_mul_u32_u24 v247, 1792, v6
    v_lshl_add_u32 v247, v2, 5, v247
    s_cmp_eq_u32 s71, 63
    s_cbranch_scc1 c1_end
    s_mov_b32 s33, 0
p5018:
    buffer_load_dwordx4 v[8:11], v247, s[28:31], s79 offen offset:0 sc1
    buffer_load_dwordx4 v[12:15], v247, s[28:31], s79 offen offset:16 sc1
    buffer_load_dwordx4 v[16:19], v247, s[28:31], s79 offen offset:128 sc1
    buffer_load_dwordx4 v[20:23], v247, s[28:31], s79 offen offset:144 sc1
    buffer_load_dwordx4 v[24:27], v247, s[28:31], s79 offen offset:256 sc1
    buffer_load_dwordx4 v[28:31], v247, s[28:31], s79 offen offset:272 sc1
    buffer_load_dwordx4 v[32:35], v247, s[28:31], s79 offen offset:384 sc1
    buffer_load_dwordx4 v[36:39], v247, s[28:31], s79 offen offset:400 sc1
    buffer_load_dwordx4 v[40:43], v247, s[28:31], s79 offen offset:512 sc1
    buffer_load_dwordx4 v[44:47], v247, s[28:31], s79 offen offset:528 sc1
    buffer_load_dwordx4 v[48:51], v247, s[28:31], s79 offen offset:640 sc1
    buffer_load_dwordx4 v[52:55], v247, s[28:31], s79 offen offset:656 sc1
    buffer_load_dwordx4 v[56:59], v247, s[28:31], s79 offen offset:768 sc1
    buffer_load_dwordx4 v[60:63], v247, s[28:31], s79 offen offset:784 sc1
    buffer_load_dwordx4 v[64:67], v247, s[28:31], s79 offen offset:896 sc1
    buffer_load_dwordx4 v[68:71], v247, s[28:31], s79 offen offset:912 sc1
    buffer_load_dwordx4 v[72:75], v247, s[28:31], s79 offen offset:1024 sc1
    buffer_load_dwordx4 v[76:79], v247, s[28:31], s79 offen offset:1040 sc1
    buffer_load_dwordx4 v[80:83], v247, s[28:31], s79 offen offset:1152 sc1
    buffer_load_dwordx4 v[84:87], v247, s[28:31], s79 offen offset:1168 sc1
    buffer_load_dwordx4 v[88:91], v247, s[28:31], s79 offen offset:1280 sc1
    buffer_load_dwordx4 v[92:95], v247, s[28:31], s79 offen offset:1296 sc1
    buffer_load_dwordx4 v[96:99], v247, s[28:31], s79 offen offset:1408 sc1
    buffer_load_dwordx4 v[100:103], v247, s[28:31], s79 offen offset:1424 sc1
    buffer_load_dwordx4 v[104:107], v247, s[28:31], s79 offen offset:1536 sc1
    buffer_load_dwordx4 v[108:111], v247, s[28:31], s79 offen offset:1552 sc1
    buffer_load_dwordx4 v[112:115], v247, s[28:31], s79 offen offset:1664 sc1
    buffer_load_dwordx4 v[116:119], v247, s[28:31], s79 offen offset:1680 sc1
    s_waitcnt vmcnt(0)
    v_xor_b32 v250, s72, v9
    v_xor_b32 v251, s72, v11
    v_or_b32 v250, v250, v251
    v_xor_b32 v251, s72, v13
    v_or_b32 v250, v250, v251
    v_xor_b32 v251, s72, v15
    v_or_b32 v250, v250, v251
    v_xor_b32 v251, s72, v17
    v_or_b32 v250, v250, v251
    v_xor_b32 v251, s72, v19
    v_or_b32 v250, v250, v251
    v_xor_b32 v251, s72, v21
    v_or_b32 v250, v250, v251
    v_xor_b32 v251, s72, v23
    v_or_b32 v250, v250, v251
    v_xor_b32 v251, s72, v25
    v_or_b32 v250, v250, v251
    v_xor_b32 v251, s72, v27
    v_or_b32 v250, v250, v251
    v_xor_b32 v251, s72, v29
    v_or_b32 v250, v250, v251
    v_xor_b32 v251, s72, v31
    v_or_b32 v250, v250, v251
    v_xor_b32 v251, s72, v33
    v_or_b32 v250, v250, v251
    v_xor_b32 v251, s72, v35
    v_or_b32 v250, v250, v251
    v_xor_b32 v251, s72, v37
    v_or_b32 v250, v250, v251
    v_xor_b32 v251, s72, v39
    v_or_b32 v250, v250, v251
    v_xor_b32 v251, s72, v41
    v_or_b32 v250, v250, v251
    v_xor_b32 v251, s72, v43
    v_or_b32 v250, v250, v251
    v_xor_b32 v251, s72, v45
    v_or_b32 v250, v250, v251
    v_xor_b32 v251, s72, v47
    v_or_b32 v250, v250, v251
    v_xor_b32 v251, s72, v49
    v_or_b32 v250, v250, v251
    v_xor_b32 v251, s72, v51
    v_or_b32 v250, v250, v251
    v_xor_b32 v251, s72, v53
    v_or_b32 v250, v250, v251
    v_xor_b32 v251, s72, v55
    v_or_b32 v250, v250, v251
    v_xor_b32 v251, s72, v57
    v_or_b32 v250, v250, v251
    v_xor_b32 v251, s72, v59
    v_or_b32 v250, v250, v251
    v_xor_b32 v251, s72, v61
    v_or_b32 v250, v250, v251
    v_xor_b32 v251, s72, v63
    v_or_b32 v250, v250, v251
    v_xor_b32 v251, s72, v65
    v_or_b32 v250, v250, v251
    v_xor_b32 v251, s72, v67
    v_or_b32 v250, v250, v251
    v_xor_b32 v251, s72, v69
    v_or_b32 v250, v250, v251
    v_xor_b32 v251, s72, v71
    v_or_b32 v250, v250, v251
    v_xor_b32 v251, s72, v73
    v_or_b32 v250, v250, v251
    v_xor_b32 v251, s72, v75
    v_or_b32 v250, v250, v251
    v_xor_b32 v251, s72, v77
    v_or_b32 v250, v250, v251
    v_xor_b32 v251, s72, v79
    v_or_b32 v250, v250, v251
    v_xor_b32 v251, s72, v81
    v_or_b32 v250, v250, v251
    v_xor_b32 v251, s72, v83
    v_or_b32 v250, v250, v251
    v_xor_b32 v251, s72, v85
    v_or_b32 v250, v250, v251
    v_xor_b32 v251, s72, v87
    v_or_b32 v250, v250, v251
    v_xor_b32 v251, s72, v89
    v_or_b32 v250, v250, v251
    v_xor_b32 v251, s72, v91
    v_or_b32 v250, v250, v251
    v_xor_b32 v251, s72, v93
    v_or_b32 v250, v250, v251
    v_xor_b32 v251, s72, v95
    v_or_b32 v250, v250, v251
    v_xor_b32 v251, s72, v97
    v_or_b32 v250, v250, v251
    v_xor_b32 v251, s72, v99
    v_or_b32 v250, v250, v251
    v_xor_b32 v251, s72, v101
    v_or_b32 v250, v250, v251
    v_xor_b32 v251, s72, v103
    v_or_b32 v250, v250, v251
    v_xor_b32 v251, s72, v105
    v_or_b32 v250, v250, v251
    v_xor_b32 v251, s72, v107
    v_or_b32 v250, v250, v251
    v_xor_b32 v251, s72, v109
    v_or_b32 v250, v250, v251
    v_xor_b32 v251, s72, v111
    v_or_b32 v250, v250, v251
    v_xor_b32 v251, s72, v113
    v_or_b32 v250, v250, v251
    v_xor_b32 v251, s72, v115
    v_or_b32 v250, v250, v251
    v_xor_b32 v251, s72, v117
    v_or_b32 v250, v250, v251
    v_xor_b32 v251, s72, v119
    v_or_b32 v250, v250, v251
    v_cmp_ne_u32 vcc, 0, v250
    s_add_u32 s33, s33, 1
    s_cmp_gt_u32 s33, 400000
    s_cbranch_scc1 p5018x
    s_nop 3
    s_cbranch_vccnz p5018
p5018x:
    v_mov_b32 v176, v8
    v_mov_b32 v177, v10
    v_mov_b32 v178, v12
    v_mov_b32 v179, v14
    v_mov_b32 v180, v16
    v_mov_b32 v181, v18
    v_mov_b32 v182, v20
    v_mov_b32 v183, v22
    v_mov_b32 v184, v24
    v_mov_b32 v185, v26
    v_mov_b32 v186, v28
    v_mov_b32 v187, v30
    v_mov_b32 v188, v32
    v_mov_b32 v189, v34
    v_mov_b32 v190, v36
    v_mov_b32 v191, v38
    v_mov_b32 v192, v40
    v_mov_b32 v193, v42
    v_mov_b32 v194, v44
    v_mov_b32 v195, v46
    v_mov_b32 v196, v48
    v_mov_b32 v197, v50
    v_mov_b32 v198, v52
    v_mov_b32 v199, v54
    v_mov_b32 v200, v56
    v_mov_b32 v201, v58
    v_mov_b32 v202, v60
    v_mov_b32 v203, v62
    v_mov_b32 v204, v64
    v_mov_b32 v205, v66
    v_mov_b32 v206, v68
    v_mov_b32 v207, v70
    v_mov_b32 v208, v72
    v_mov_b32 v209, v74
    v_mov_b32 v210, v76
    v_mov_b32 v211, v78
    v_mov_b32 v212, v80
    v_mov_b32 v213, v82
    v_mov_b32 v214, v84
    v_mov_b32 v215, v86
    v_mov_b32 v216, v88
    v_mov_b32 v217, v90
    v_mov_b32 v218, v92
    v_mov_b32 v219, v94
    v_mov_b32 v220, v96
    v_mov_b32 v221, v98
    v_mov_b32 v222, v100
    v_mov_b32 v223, v102
    v_mov_b32 v224, v104
    v_mov_b32 v225, v106
    v_mov_b32 v226, v108
    v_mov_b32 v227, v110
    v_mov_b32 v228, v112
    v_mov_b32 v229, v114
    v_mov_b32 v230, v116
    v_mov_b32 v231, v118
    s_add_u32 s71, s71, 1
    s_branch c1_loop
c1_end:
    s_endpgm
.globl go2_kernel
.p2align 8
.type go2_kernel,@function
go2_kernel:
    s_load_dwordx16 s[36:51], s[0:1], 0
    s_load_dwordx8 s[52:59], s[0:1], 64
    s_load_dwordx2 s[60:61], s[0:1], 104
    s_load_dwordx2 s[62:63], s[0:1], 120
    s_waitcnt lgkmcnt(0)
    s_cmp_ge_u32 s2, 112
    s_cbranch_scc1 go2_end
    s_add_u32 s12, s62, 100663296
    s_addc_u32 s13, s63, 0
    s_mov_b32 s14, 16777216
    s_mov_b32 s15, 0x20000
    s_add_u32 s16, s62, 29360128
    s_addc_u32 s17, s63, 0
    s_mov_b32 s18, 3670016
    s_mov_b32 s19, 0x20000
    s_mov_b32 s20, s60
    s_mov_b32 s21, s61
    s_mov_b32 s22, 1835008
    s_mov_b32 s23, 0x20000
    s_add_u32 s24, s62, 4194304
    s_addc_u32 s25, s63, 0
    s_mov_b32 s26, 1835008
    s_mov_b32 s27, 0x20000
    s_and_b32 s4, s2, 15
    s_lshr_b32 s5, s2, 4
    v_and_b32 v1, 31, v0
    v_bfe_u32 v2, v0, 5, 1
    v_bfe_u32 v3, v0, 6, 1
    v_lshrrev_b32 v4, 7, v0
    s_lshl_b32 s6, s4, 7
    v_lshl_add_u32 v5, v4, 6, v1
    v_add_u32 v5, s6, v5
    s_lshl_b32 s7, s5, 6
    v_lshl_add_u32 v6, v3, 5, v1
    v_add_u32 v6, s7, v6
    s_mov_b32 s8, 8192
    v_mul_lo_u32 v7, v5, s8
    v_lshl_add_u32 v7, v2, 4, v7
    v_add_u32 v8, 262144, v7
    v_mul_lo_u32 v9, v6, s8
    v_lshl_add_u32 v9, v2, 4, v9
    v_mov_b32 v16, 0
    v_mov_b32 v17, 0
    v_mov_b32 v18, 0
    v_mov_b32 v19, 0
    v_mov_b32 v20, 0
    v_mov_b32 v21, 0
    v_mov_b32 v22, 0
    v_mov_b32 v23, 0
    v_mov_b32 v24, 0
    v_mov_b32 v25, 0
    v_mov_b32 v26, 0
    v_mov_b32 v27, 0
    v_mov_b32 v28, 0
    v_mov_b32 v29, 0
    v_mov_b32 v30, 0
    v_mov_b32 v31, 0
    v_mov_b32 v32, 0
    v_mov_b32 v33, 0
    v_mov_b32 v34, 0
    v_mov_b32 v35, 0
    v_mov_b32 v36, 0
    v_mov_b32 v37, 0
    v_mov_b32 v38, 0
    v_mov_b32 v39, 0
    v_mov_b32 v40, 0
    v_mov_b32 v41, 0
    v_mov_b32 v42, 0
    v_mov_b32 v43, 0
    v_mov_b32 v44, 0
    v_mov_b32 v45, 0
    v_mov_b32 v46, 0
    v_mov_b32 v47, 0
    s_mov_b32 s9, 0
go2_loop:
    buffer_load_dwordx4 v[48:51], v9, s[16:19], s9 offen offset:0
    buffer_load_dwordx4 v[52:55], v7, s[12:15], s9 offen offset:0
    buffer_load_dwordx4 v[56:59], v8, s[12:15], s9 offen offset:0
    buffer_load_dwordx4 v[60:63], v9, s[16:19], s9 offen offset:32
    buffer_load_dwordx4 v[64:67], v7, s[12:15], s9 offen offset:32
    buffer_load_dwordx4 v[68:71], v8, s[12:15], s9 offen offset:32
    buffer_load_dwordx4 v[72:75], v9, s[16:19], s9 offen offset:64
    buffer_load_dwordx4 v[76:79], v7, s[12:15], s9 offen offset:64
    buffer_load_dwordx4 v[80:83], v8, s[12:15], s9 offen offset:64
    buffer_load_dwordx4 v[84:87], v9, s[16:19], s9 offen offset:96
    buffer_load_dwordx4 v[88:91], v7, s[12:15], s9 offen offset:96
    buffer_load_dwordx4 v[92:95], v8, s[12:15], s9 offen offset:96
    s_waitcnt vmcnt(9)
    v_mfma_f32_32x32x16_bf16 v[16:31], v[48:51], v[52:55], v[16:31]
    v_mfma_f32_32x32x16_bf16 v[32:47], v[48:51], v[56:59], v[32:47]
    s_waitcnt vmcnt(6)
    v_mfma_f32_32x32x16_bf16 v[16:31], v[60:63], v[64:67], v[16:31]
    v_mfma_f32_32x32x16_bf16 v[32:47], v[60:63], v[68:71], v[32:47]
    s_waitcnt vmcnt(3)
    v_mfma_f32_32x32x16_bf16 v[16:31], v[72:75], v[76:79], v[16:31]
    v_mfma_f32_32x32x16_bf16 v[32:47], v[72:75], v[80:83], v[32:47]
    s_waitcnt vmcnt(0)
    v_mfma_f32_32x32x16_bf16 v[16:31], v[84:87], v[88:91], v[16:31]
    v_mfma_f32_32x32x16_bf16 v[32:47], v[84:87], v[92:95], v[32:47]
    s_add_u32 s9, s9, 128
    s_cmp_lt_u32 s9, 8192
    s_cbranch_scc1 go2_loop
    s_nop 15
    s_mov_b32 s8, 896
    v_mul_lo_u32 v7, v5, s8
    v_lshl_add_u32 v10, v3, 5, 0
    v_add_u32 v10, s7, v10
    v_lshl_add_u32 v10, v2, 2, v10
    v_lshl_add_u32 v7, v10, 1, v7
    v_add_u32 v8, 0, v7
    buffer_load_dwordx2 v[10:11], v8, s[24:27], 0 offen
    v_cvt_pk_bf16_f32 v16, v16, v16
    v_lshlrev_b32 v16, 16, v16
    v_cvt_pk_bf16_f32 v17, v17, v17
    v_lshlrev_b32 v17, 16, v17
    v_cvt_pk_bf16_f32 v18, v18, v18
    v_lshlrev_b32 v18, 16, v18
    v_cvt_pk_bf16_f32 v19, v19, v19
    v_lshlrev_b32 v19, 16, v19
    s_waitcnt vmcnt(0)
    v_lshlrev_b32 v12, 16, v10
    v_and_b32 v13, 0xffff0000, v10
    v_lshlrev_b32 v14, 16, v11
    v_and_b32 v15, 0xffff0000, v11
    v_add_f32 v16, v16, v12
    v_add_f32 v17, v17, v13
    v_add_f32 v18, v18, v14
    v_add_f32 v19, v19, v15
    v_cvt_pk_bf16_f32 v10, v16, v17
    v_cvt_pk_bf16_f32 v11, v18, v19
    buffer_store_dwordx2 v[10:11], v8, s[20:23], 0 offen
    s_nop 1
    v_add_u32 v8, 16, v7
    buffer_load_dwordx2 v[10:11], v8, s[24:27], 0 offen
    v_cvt_pk_bf16_f32 v20, v20, v20
    v_lshlrev_b32 v20, 16, v20
    v_cvt_pk_bf16_f32 v21, v21, v21
    v_lshlrev_b32 v21, 16, v21
    v_cvt_pk_bf16_f32 v22, v22, v22
    v_lshlrev_b32 v22, 16, v22
    v_cvt_pk_bf16_f32 v23, v23, v23
    v_lshlrev_b32 v23, 16, v23
    s_waitcnt vmcnt(0)
    v_lshlrev_b32 v12, 16, v10
    v_and_b32 v13, 0xffff0000, v10
    v_lshlrev_b32 v14, 16, v11
    v_and_b32 v15, 0xffff0000, v11
    v_add_f32 v20, v20, v12
    v_add_f32 v21, v21, v13
    v_add_f32 v22, v22, v14
    v_add_f32 v23, v23, v15
    v_cvt_pk_bf16_f32 v10, v20, v21
    v_cvt_pk_bf16_f32 v11, v22, v23
    buffer_store_dwordx2 v[10:11], v8, s[20:23], 0 offen
    s_nop 1
    v_add_u32 v8, 32, v7
    buffer_load_dwordx2 v[10:11], v8, s[24:27], 0 offen
    v_cvt_pk_bf16_f32 v24, v24, v24
    v_lshlrev_b32 v24, 16, v24
    v_cvt_pk_bf16_f32 v25, v25, v25
    v_lshlrev_b32 v25, 16, v25
    v_cvt_pk_bf16_f32 v26, v26, v26
    v_lshlrev_b32 v26, 16, v26
    v_cvt_pk_bf16_f32 v27, v27, v27
    v_lshlrev_b32 v27, 16, v27
    s_waitcnt vmcnt(0)
    v_lshlrev_b32 v12, 16, v10
    v_and_b32 v13, 0xffff0000, v10
    v_lshlrev_b32 v14, 16, v11
    v_and_b32 v15, 0xffff0000, v11
    v_add_f32 v24, v24, v12
    v_add_f32 v25, v25, v13
    v_add_f32 v26, v26, v14
    v_add_f32 v27, v27, v15
    v_cvt_pk_bf16_f32 v10, v24, v25
    v_cvt_pk_bf16_f32 v11, v26, v27
    buffer_store_dwordx2 v[10:11], v8, s[20:23], 0 offen
    s_nop 1
    v_add_u32 v8, 48, v7
    buffer_load_dwordx2 v[10:11], v8, s[24:27], 0 offen
    v_cvt_pk_bf16_f32 v28, v28, v28
    v_lshlrev_b32 v28, 16, v28
    v_cvt_pk_bf16_f32 v29, v29, v29
    v_lshlrev_b32 v29, 16, v29
    v_cvt_pk_bf16_f32 v30, v30, v30
    v_lshlrev_b32 v30, 16, v30
    v_cvt_pk_bf16_f32 v31, v31, v31
    v_lshlrev_b32 v31, 16, v31
    s_waitcnt vmcnt(0)
    v_lshlrev_b32 v12, 16, v10
    v_and_b32 v13, 0xffff0000, v10
    v_lshlrev_b32 v14, 16, v11
    v_and_b32 v15, 0xffff0000, v11
    v_add_f32 v28, v28, v12
    v_add_f32 v29, v29, v13
    v_add_f32 v30, v30, v14
    v_add_f32 v31, v31, v15
    v_cvt_pk_bf16_f32 v10, v28, v29
    v_cvt_pk_bf16_f32 v11, v30, v31
    buffer_store_dwordx2 v[10:11], v8, s[20:23], 0 offen
    s_nop 1
    v_add_u32 v8, 28672, v7
    buffer_load_dwordx2 v[10:11], v8, s[24:27], 0 offen
    v_cvt_pk_bf16_f32 v32, v32, v32
    v_lshlrev_b32 v32, 16, v32
    v_cvt_pk_bf16_f32 v33, v33, v33
    v_lshlrev_b32 v33, 16, v33
    v_cvt_pk_bf16_f32 v34, v34, v34
    v_lshlrev_b32 v34, 16, v34
    v_cvt_pk_bf16_f32 v35, v35, v35
    v_lshlrev_b32 v35, 16, v35
    s_waitcnt vmcnt(0)
    v_lshlrev_b32 v12, 16, v10
    v_and_b32 v13, 0xffff0000, v10
    v_lshlrev_b32 v14, 16, v11
    v_and_b32 v15, 0xffff0000, v11
    v_add_f32 v32, v32, v12
    v_add_f32 v33, v33, v13
    v_add_f32 v34, v34, v14
    v_add_f32 v35, v35, v15
    v_cvt_pk_bf16_f32 v10, v32, v33
    v_cvt_pk_bf16_f32 v11, v34, v35
    buffer_store_dwordx2 v[10:11], v8, s[20:23], 0 offen
    s_nop 1
    v_add_u32 v8, 28688, v7
    buffer_load_dwordx2 v[10:11], v8, s[24:27], 0 offen
    v_cvt_pk_bf16_f32 v36, v36, v36
    v_lshlrev_b32 v36, 16, v36
    v_cvt_pk_bf16_f32 v37, v37, v37
    v_lshlrev_b32 v37, 16, v37
    v_cvt_pk_bf16_f32 v38, v38, v38
    v_lshlrev_b32 v38, 16, v38
    v_cvt_pk_bf16_f32 v39, v39, v39
    v_lshlrev_b32 v39, 16, v39
    s_waitcnt vmcnt(0)
    v_lshlrev_b32 v12, 16, v10
    v_and_b32 v13, 0xffff0000, v10
    v_lshlrev_b32 v14, 16, v11
    v_and_b32 v15, 0xffff0000, v11
    v_add_f32 v36, v36, v12
    v_add_f32 v37, v37, v13
    v_add_f32 v38, v38, v14
    v_add_f32 v39, v39, v15
    v_cvt_pk_bf16_f32 v10, v36, v37
    v_cvt_pk_bf16_f32 v11, v38, v39
    buffer_store_dwordx2 v[10:11], v8, s[20:23], 0 offen
    s_nop 1
    v_add_u32 v8, 28704, v7
    buffer_load_dwordx2 v[10:11], v8, s[24:27], 0 offen
    v_cvt_pk_bf16_f32 v40, v40, v40
    v_lshlrev_b32 v40, 16, v40
    v_cvt_pk_bf16_f32 v41, v41, v41
    v_lshlrev_b32 v41, 16, v41
    v_cvt_pk_bf16_f32 v42, v42, v42
    v_lshlrev_b32 v42, 16, v42
    v_cvt_pk_bf16_f32 v43, v43, v43
    v_lshlrev_b32 v43, 16, v43
    s_waitcnt vmcnt(0)
    v_lshlrev_b32 v12, 16, v10
    v_and_b32 v13, 0xffff0000, v10
    v_lshlrev_b32 v14, 16, v11
    v_and_b32 v15, 0xffff0000, v11
    v_add_f32 v40, v40, v12
    v_add_f32 v41, v41, v13
    v_add_f32 v42, v42, v14
    v_add_f32 v43, v43, v15
    v_cvt_pk_bf16_f32 v10, v40, v41
    v_cvt_pk_bf16_f32 v11, v42, v43
    buffer_store_dwordx2 v[10:11], v8, s[20:23], 0 offen
    s_nop 1
    v_add_u32 v8, 28720, v7
    buffer_load_dwordx2 v[10:11], v8, s[24:27], 0 offen
    v_cvt_pk_bf16_f32 v44, v44, v44
    v_lshlrev_b32 v44, 16, v44
    v_cvt_pk_bf16_f32 v45, v45, v45
    v_lshlrev_b32 v45, 16, v45
    v_cvt_pk_bf16_f32 v46, v46, v46
    v_lshlrev_b32 v46, 16, v46
    v_cvt_pk_bf16_f32 v47, v47, v47
    v_lshlrev_b32 v47, 16, v47
    s_waitcnt vmcnt(0)
    v_lshlrev_b32 v12, 16, v10
    v_and_b32 v13, 0xffff0000, v10
    v_lshlrev_b32 v14, 16, v11
    v_and_b32 v15, 0xffff0000, v11
    v_add_f32 v44, v44, v12
    v_add_f32 v45, v45, v13
    v_add_f32 v46, v46, v14
    v_add_f32 v47, v47, v15
    v_cvt_pk_bf16_f32 v10, v44, v45
    v_cvt_pk_bf16_f32 v11, v46, v47
    buffer_store_dwordx2 v[10:11], v8, s[20:23], 0 offen
    s_nop 1
go2_end:
    s_endpgm
.section .rodata,"a"
.p2align 6
.amdhsa_kernel zero_kernel
  .amdhsa_next_free_vgpr 128
  .amdhsa_next_free_sgpr 102
  .amdhsa_accum_offset 128
  .amdhsa_group_segment_fixed_size 0
  .amdhsa_kernarg_size 128
  .amdhsa_user_sgpr_count 2
  .amdhsa_user_sgpr_kernarg_segment_ptr 1
  .amdhsa_system_sgpr_workgroup_id_x 1
.end_amdhsa_kernel
.p2align 6
.amdhsa_kernel prep_kernel
  .amdhsa_next_free_vgpr 128
  .amdhsa_next_free_sgpr 102
  .amdhsa_accum_offset 128
  .amdhsa_group_segment_fixed_size 0
  .amdhsa_kernarg_size 128
  .amdhsa_user_sgpr_count 2
  .amdhsa_user_sgpr_kernarg_segment_ptr 1
  .amdhsa_system_sgpr_workgroup_id_x 1
.end_amdhsa_kernel
.p2align 6
.amdhsa_kernel conv_kernel
  .amdhsa_next_free_vgpr 128
  .amdhsa_next_free_sgpr 102
  .amdhsa_accum_offset 128
  .amdhsa_group_segment_fixed_size 0
  .amdhsa_kernarg_size 128
  .amdhsa_user_sgpr_count 2
  .amdhsa_user_sgpr_kernarg_segment_ptr 1
  .amdhsa_system_sgpr_workgroup_id_x 1
.end_amdhsa_kernel
.p2align 6
.amdhsa_kernel row0_kernel
  .amdhsa_next_free_vgpr 128
  .amdhsa_next_free_sgpr 102
  .amdhsa_accum_offset 128
  .amdhsa_group_segment_fixed_size 0
  .amdhsa_kernarg_size 128
  .amdhsa_user_sgpr_count 2
  .amdhsa_user_sgpr_kernarg_segment_ptr 1
  .amdhsa_system_sgpr_workgroup_id_x 1
.end_amdhsa_kernel
.p2align 6
.amdhsa_kernel gqkv_kernel
  .amdhsa_next_free_vgpr 128
  .amdhsa_next_free_sgpr 102
  .amdhsa_accum_offset 128
  .amdhsa_group_segment_fixed_size 0
  .amdhsa_kernarg_size 128
  .amdhsa_user_sgpr_count 2
  .amdhsa_user_sgpr_kernarg_segment_ptr 1
  .amdhsa_system_sgpr_workgroup_id_x 1
.end_amdhsa_kernel
.p2align 6
.amdhsa_kernel chain0_kernel
  .amdhsa_next_free_vgpr 480
  .amdhsa_next_free_sgpr 102
  .amdhsa_accum_offset 256
  .amdhsa_group_segment_fixed_size 0
  .amdhsa_kernarg_size 128
  .amdhsa_user_sgpr_count 2
  .amdhsa_user_sgpr_kernarg_segment_ptr 1
  .amdhsa_system_sgpr_workgroup_id_x 1
.end_amdhsa_kernel
.p2align 6
.amdhsa_kernel attn_kernel
  .amdhsa_next_free_vgpr 128
  .amdhsa_next_free_sgpr 102
  .amdhsa_accum_offset 128
  .amdhsa_group_segment_fixed_size 0
  .amdhsa_kernarg_size 128
  .amdhsa_user_sgpr_count 2
  .amdhsa_user_sgpr_kernarg_segment_ptr 1
  .amdhsa_system_sgpr_workgroup_id_x 1
.end_amdhsa_kernel
.p2align 6
.amdhsa_kernel go1_kernel
  .amdhsa_next_free_vgpr 128
  .amdhsa_next_free_sgpr 102
  .amdhsa_accum_offset 128
  .amdhsa_group_segment_fixed_size 0
  .amdhsa_kernarg_size 128
  .amdhsa_user_sgpr_count 2
  .amdhsa_user_sgpr_kernarg_segment_ptr 1
  .amdhsa_system_sgpr_workgroup_id_x 1
.end_amdhsa_kernel
.p2align 6
.amdhsa_kernel row1_kernel
  .amdhsa_next_free_vgpr 128
  .amdhsa_next_free_sgpr 102
  .amdhsa_accum_offset 128
  .amdhsa_group_segment_fixed_size 0
  .amdhsa_kernarg_size 128
  .amdhsa_user_sgpr_count 2
  .amdhsa_user_sgpr_kernarg_segment_ptr 1
  .amdhsa_system_sgpr_workgroup_id_x 1
.end_amdhsa_kernel
.p2align 6
.amdhsa_kernel chain1_kernel
  .amdhsa_next_free_vgpr 480
  .amdhsa_next_free_sgpr 102
  .amdhsa_accum_offset 256
  .amdhsa_group_segment_fixed_size 0
  .amdhsa_kernarg_size 128
  .amdhsa_user_sgpr_count 2
  .amdhsa_user_sgpr_kernarg_segment_ptr 1
  .amdhsa_system_sgpr_workgroup_id_x 1
.end_amdhsa_kernel
.p2align 6
.amdhsa_kernel go2_kernel
  .amdhsa_next_free_vgpr 128
  .amdhsa_next_free_sgpr 102
  .amdhsa_accum_offset 128
  .amdhsa_group_segment_fixed_size 0
  .amdhsa_kernarg_size 128
  .amdhsa_user_sgpr_count 2
  .amdhsa_user_sgpr_kernarg_segment_ptr 1
  .amdhsa_system_sgpr_workgroup_id_x 1
.end_amdhsa_kernel
```
